```python
import torch

def _softmax(x, axis=-1):
    return torch.softmax(x, dim=axis)
def _gelu(x):
    return torch.nn.functional.gelu(x, approximate="tanh")
def _silu(x):
    return torch.nn.functional.silu(x)
def _sigmoid(x):
    return torch.sigmoid(x)
def _layernorm(x, axis=-1, eps=1e-5):
    m = x.mean(dim=axis, keepdim=True)
    v = x.var(dim=axis, keepdim=True, unbiased=False)
    return (x - m) / torch.sqrt(v + eps)
def _scatter_add(tgt, idx, src, axis=0):
    return tgt.clone().index_add_(axis, idx, src)
def _segment_sum(src, seg, n):
    out = torch.zeros((n,) + src.shape[1:], dtype=src.dtype)
    return out.index_add_(0, seg, src)
def _pad(x, pw):
    flat = tuple(v for pair in reversed(pw) for v in pair)
    return torch.nn.functional.pad(x, flat)

kernel_name = 'gated_mix__spectral_gfnet__dense_activation_mish__prompt'

def setup_inputs():

    _w = (lambda a: (lambda t: t.to(torch.bfloat16) if t.is_floating_point() else t)(torch.as_tensor(a)))
    def _A_setup():
        B, S, D = 1, 2048, 512
        Df = D // 2 + 1
        return {
            "x": _w((lambda *s: torch.randn(*s, dtype=torch.bfloat16) * 0.05)(B, S, D)),
            "w_r": _w((lambda *s: torch.randn(*s, dtype=torch.bfloat16) * 1.6)(S, Df) * 0.02),
            "w_i": _w((lambda *s: torch.randn(*s, dtype=torch.bfloat16) * 1.6)(S, Df) * 0.02),
        }
    _A_in = _A_setup()

    def _B_setup():
        B, S, D, F = 1, 2048, 512, 1792
        return {
            "x": _w((lambda *s: torch.randn(*s, dtype=torch.bfloat16) * 0.05)(B, S, D)),
            "w1": _w((lambda *s: torch.randn(*s, dtype=torch.bfloat16) * 6.4)(D, F) * (D ** -0.5)),
            "b1": _w((lambda *s: torch.randn(*s, dtype=torch.bfloat16) * 0.05)(F)),
            "w2": _w((lambda *s: torch.randn(*s, dtype=torch.bfloat16) * 0.05)(F, D) * (F ** -0.5)),
        }
    _B_in = _B_setup()

    return {
        "A_x": _A_in["x"],
        "A_w_r": _A_in["w_r"],
        "A_w_i": _A_in["w_i"],
        "B_x": _B_in["x"],
        "B_w1": _B_in["w1"],
        "B_b1": _B_in["b1"],
        "B_w2": _B_in["w2"],
        "gate_w": _w((lambda *s: torch.randn(*s, dtype=torch.bfloat16) * 0.05)(512) * 16.0),
    }

def reference(A_x, A_w_r, A_w_i, B_x, B_w1, B_b1, B_w2, gate_w):
    def _A_ref(x, w_r, w_i):
        B, S, D = x.shape
        X = (lambda x, axes=(-2,-1): torch.fft.rfft2(x.float(), dim=axes))(x, axes=(-2, -1))
        W = w_r + 1j * w_i
        X = X * W
        y = (lambda x, s, axes=(-2,-1): torch.fft.irfft2(x, s=s, dim=axes).to(torch.bfloat16))(X, (S, D), axes=(-2, -1))
        return y

    def _B_ref(x, w1, b1, w2):
        h = torch.einsum("bsd,df->bsf", x, w1) + b1
        sp = torch.log1p(torch.exp(-torch.abs(h))) + torch.where(h > 0, h, torch.zeros_like(h))
        act = h * torch.tanh(sp)
        return torch.einsum("bsf,fd->bsd", act, w2)

    x = A_x
    g = _sigmoid((x * gate_w).sum(-1, keepdims=True))
    a = _A_ref(x, A_w_r, A_w_i)
    b = _B_ref(x, B_w1, B_b1, B_w2)
    return g * a + (1 - g) * b
```

```asm
; @launch grid=(256,1,1) block=(512,1,1) lds=163840
.amdgcn_target "amdgcn-amd-amdhsa--gfx950"
.text
.globl gated_mix__spectral_gfnet__dense_activation_mish__prompt_kernel
.p2align 8
.type gated_mix__spectral_gfnet__dense_activation_mish__prompt_kernel,@function
gated_mix__spectral_gfnet__dense_activation_mish__prompt_kernel:
  s_cmp_ge_u32 s2, 256
  s_cbranch_scc1 L_end
  s_load_dwordx2 s[8:9], s[0:1], 0
  s_load_dwordx2 s[12:13], s[0:1], 8
  s_load_dwordx2 s[16:17], s[0:1], 16
  s_load_dwordx2 s[20:21], s[0:1], 32
  s_load_dwordx2 s[24:25], s[0:1], 40
  s_load_dwordx2 s[28:29], s[0:1], 48
  s_load_dwordx2 s[32:33], s[0:1], 56
  s_load_dwordx2 s[36:37], s[0:1], 64
  s_load_dwordx2 s[40:41], s[0:1], 80
  s_load_dwordx2 s[44:45], s[0:1], 72
  s_getpc_b64 s[64:65]
  v_lshrrev_b32 v56, 6, v0
  v_and_b32 v57, 63, v0
  v_readfirstlane_b32 s66, v56
  v_lshlrev_b32 v57, 4, v57
  s_lshr_b32 s67, s2, 3
  s_mul_i32 s67, s67, 8
  s_add_u32 s67, s67, s66
  s_lshl_b32 s68, s67, 10
  s_add_u32 s64, s64, s68
  s_addc_u32 s65, s65, 0
  v_mov_b32 v59, s65
  v_add_co_u32 v58, vcc, s64, v57
  s_nop 1
  v_addc_co_u32 v59, vcc, 0, v59, vcc
  s_cmp_lt_u32 s66, 8
  s_cbranch_scc0 L_nopf0
  s_cmp_lt_u32 s67, 27
  s_cbranch_scc0 L_nopf0
  global_load_dwordx4 v[52:55], v[58:59], off
L_nopf0:
  v_lshrrev_b32 v1, 6, v0
  v_and_b32 v0, 63, v0
  v_readfirstlane_b32 s48, v1
  v_and_b32 v1, 15, v0
  v_lshrrev_b32 v2, 4, v0
  v_lshlrev_b32 v3, 4, v0
  s_mov_b32 s10, 0x200000
  s_mov_b32 s11, 0x20000
  s_mov_b32 s14, 0x101000
  s_mov_b32 s15, 0x20000
  s_mov_b32 s18, 0x101000
  s_mov_b32 s19, 0x20000
  s_mov_b32 s22, 0x1c0000
  s_mov_b32 s23, 0x20000
  s_mov_b32 s26, 0xe00
  s_mov_b32 s27, 0x20000
  s_mov_b32 s30, 0x1c0000
  s_mov_b32 s31, 0x20000
  s_mov_b32 s34, 0x400
  s_mov_b32 s35, 0x20000
  s_mov_b32 s38, 0x200000
  s_mov_b32 s39, 0x20000
  s_mov_b32 s42, 0x1080000
  s_mov_b32 s43, 0x20000
  s_mov_b32 s46, 0x100
  s_mov_b32 s47, 0x20000
  s_mov_b32 s51, s48
  s_and_b32 s3, s48, 3
  s_lshr_b32 s50, s48, 2
  s_and_b32 s4, s2, 7
  s_lshr_b32 s5, s2, 3
  s_lshr_b32 s6, s4, 1
  s_lshl_b32 s6, s6, 2
  s_lshr_b32 s56, s5, 3
  s_add_u32 s6, s6, s56
  s_and_b32 s7, s4, 1
  s_lshl_b32 s7, s7, 3
  s_and_b32 s56, s5, 7
  s_add_u32 s7, s7, s56
  s_and_b32 s48, s7, 1
  s_waitcnt lgkmcnt(0)
  v_lshlrev_b32 v5, 7, v0
  v_mov_b32 v6, 1073741824
  v_cmp_gt_u32 vcc, 56, v0
  s_nop 1
  v_cndmask_b32 v6, v6, v5, vcc
  s_cmp_eq_u32 s51, 0
  s_cselect_b32 s56, 0, 1073741824
  v_add_u32 v5, s56, v5
  s_cmp_eq_u32 s51, 1
  s_cselect_b32 s56, 0, 1073741824
  v_add_u32 v7, s56, v6
  s_lshl_b32 s56, s2, 13
  s_mul_i32 s57, s2, 7168
  buffer_load_dword v245, v7, s[20:23], s57 offen
  s_cmp_eq_u32 s50, 0
  s_cbranch_scc1 L_M
L_F:
  s_mov_b32 s90, 1
  s_setprio 2
  s_lshr_b32 s49, s2, 5
  s_and_b32 s50, s2, 31
  s_lshl_b32 s51, s6, 17
  s_lshl_b32 s56, s3, 13
  s_add_u32 s51, s51, s56
  s_mul_i32 s52, s7, 224
  s_mul_i32 s56, s3, 14336
  s_add_u32 s52, s52, s56
  s_lshl_b32 s53, s3, 10
  s_mul_i32 s54, s3, 960
  s_add_u32 s54, s54, 16384
  v_lshrrev_b32 v6, 3, v0
  v_lshlrev_b32 v4, 10, v6
  v_lshrrev_b32 v6, 1, v6
  s_and_b32 s56, s3, 1
  s_lshl_b32 s56, s56, 2
  v_add_u32 v6, s56, v6
  v_and_b32 v7, 7, v0
  v_xor_b32 v6, v6, v7
  v_lshl_add_u32 v4, v6, 4, v4
  v_mul_u32_u24 v6, 4682, v0
  v_lshrrev_b32 v6, 16, v6
  v_mul_u32_u24 v5, 3584, v6
  v_mul_u32_u24 v6, 14, v6
  v_sub_u32 v6, v0, v6
  v_lshl_add_u32 v5, v6, 4, v5
  v_mov_b32 v248, 160768
  s_lshl_b32 s56, s49, 18
  s_lshl_b32 s57, s50, 10
  s_add_u32 s56, s56, s57
  s_lshl_b32 s57, s3, 16
  s_add_u32 s56, s56, s57
  s_add_u32 s58, s56, 32768
  s_mul_i32 s57, s3, 2304
  s_add_u32 s57, s57, 126976
  s_waitcnt lgkmcnt(0)
  s_cmp_lg_u32 s3, 0
  s_cbranch_scc1 L_a_r0
  s_mov_b32 m0, 158720
  s_nop 0
  buffer_load_dwordx4 v3, s[32:35], 0 offen lds
L_a_r0:
  s_cmp_lg_u32 s3, 1
  s_cbranch_scc1 L_a_r1
  s_mul_i32 s64, s7, 224
  s_mov_b32 m0, 159744
  s_mov_b64 exec, 0x3fff
  buffer_load_dwordx4 v3, s[24:27], s64 offen lds
  s_mov_b64 exec, -1
L_a_r1:
  s_mov_b32 m0, s57
  s_add_u32 s57, s57, 1152
  buffer_load_dwordx4 v3, s[8:11], s56 offen lds
  s_mov_b32 m0, s57
  s_nop 0
  buffer_load_dwordx4 v3, s[8:11], s58 offen lds
  s_lshl_b32 s65, s49, 2
  s_xor_b32 s66, s3, 2
  s_or_b32 s66, s66, s65
  s_add_u32 m0, s53, 0
  s_add_u32 s55, s51, 0
  buffer_load_dwordx4 v4, s[8:11], s55 offen lds
  s_add_u32 m0, s53, 4096
  s_add_u32 s55, s51, 32768
  buffer_load_dwordx4 v4, s[8:11], s55 offen lds
  s_add_u32 m0, s53, 8192
  s_add_u32 s55, s51, 65536
  buffer_load_dwordx4 v4, s[8:11], s55 offen lds
  s_add_u32 m0, s53, 12288
  s_add_u32 s55, s51, 98304
  buffer_load_dwordx4 v4, s[8:11], s55 offen lds
  s_add_u32 m0, s54, 0
  s_add_u32 s55, s52, 0
  s_mov_b32 exec_hi, 0x00ffffff
  buffer_load_dwordx4 v5, s[20:23], s55 offen lds
  s_mov_b32 exec_hi, -1
  s_add_u32 m0, s54, 3840
  s_add_u32 s55, s52, 57344
  s_mov_b32 exec_hi, 0x00ffffff
  buffer_load_dwordx4 v5, s[20:23], s55 offen lds
  s_mov_b32 exec_hi, -1
  s_add_u32 m0, s54, 7680
  s_add_u32 s55, s52, 114688
  s_mov_b32 exec_hi, 0x00ffffff
  buffer_load_dwordx4 v5, s[20:23], s55 offen lds
  s_mov_b32 exec_hi, -1
  s_add_u32 m0, s54, 11520
  s_add_u32 s55, s52, 172032
  s_mov_b32 exec_hi, 0x00ffffff
  buffer_load_dwordx4 v5, s[20:23], s55 offen lds
  s_mov_b32 exec_hi, -1
  s_add_u32 m0, s53, 31744
  s_add_u32 s55, s51, 128
  buffer_load_dwordx4 v4, s[8:11], s55 offen lds
  s_add_u32 m0, s53, 35840
  s_add_u32 s55, s51, 32896
  buffer_load_dwordx4 v4, s[8:11], s55 offen lds
  s_add_u32 m0, s53, 39936
  s_add_u32 s55, s51, 65664
  buffer_load_dwordx4 v4, s[8:11], s55 offen lds
  s_add_u32 m0, s53, 44032
  s_add_u32 s55, s51, 98432
  buffer_load_dwordx4 v4, s[8:11], s55 offen lds
  s_add_u32 m0, s54, 31744
  s_add_u32 s55, s52, 229376
  s_mov_b32 exec_hi, 0x00ffffff
  buffer_load_dwordx4 v5, s[20:23], s55 offen lds
  s_mov_b32 exec_hi, -1
  s_add_u32 m0, s54, 35584
  s_add_u32 s55, s52, 286720
  s_mov_b32 exec_hi, 0x00ffffff
  buffer_load_dwordx4 v5, s[20:23], s55 offen lds
  s_mov_b32 exec_hi, -1
  s_add_u32 m0, s54, 39424
  s_add_u32 s55, s52, 344064
  s_mov_b32 exec_hi, 0x00ffffff
  buffer_load_dwordx4 v5, s[20:23], s55 offen lds
  s_mov_b32 exec_hi, -1
  s_add_u32 m0, s54, 43264
  s_add_u32 s55, s52, 401408
  s_mov_b32 exec_hi, 0x00ffffff
  buffer_load_dwordx4 v5, s[20:23], s55 offen lds
  s_mov_b32 exec_hi, -1
  s_setprio 0
  s_waitcnt vmcnt(16)
  s_barrier
  s_add_u32 m0, s53, 63488
  s_add_u32 s55, s51, 256
  buffer_load_dwordx4 v4, s[8:11], s55 offen lds
  s_add_u32 m0, s53, 67584
  s_add_u32 s55, s51, 33024
  buffer_load_dwordx4 v4, s[8:11], s55 offen lds
  s_add_u32 m0, s53, 71680
  s_add_u32 s55, s51, 65792
  buffer_load_dwordx4 v4, s[8:11], s55 offen lds
  s_add_u32 m0, s53, 75776
  s_add_u32 s55, s51, 98560
  buffer_load_dwordx4 v4, s[8:11], s55 offen lds
  s_add_u32 m0, s54, 63488
  s_add_u32 s55, s52, 458752
  s_mov_b32 exec_hi, 0x00ffffff
  buffer_load_dwordx4 v5, s[20:23], s55 offen lds
  s_mov_b32 exec_hi, -1
  s_add_u32 m0, s54, 67328
  s_add_u32 s55, s52, 516096
  s_mov_b32 exec_hi, 0x00ffffff
  buffer_load_dwordx4 v5, s[20:23], s55 offen lds
  s_mov_b32 exec_hi, -1
  s_add_u32 m0, s54, 71168
  s_add_u32 s55, s52, 573440
  s_mov_b32 exec_hi, 0x00ffffff
  buffer_load_dwordx4 v5, s[20:23], s55 offen lds
  s_mov_b32 exec_hi, -1
  s_add_u32 m0, s54, 75008
  s_add_u32 s55, s52, 630784
  s_mov_b32 exec_hi, 0x00ffffff
  buffer_load_dwordx4 v5, s[20:23], s55 offen lds
  s_mov_b32 exec_hi, -1
  s_lshr_b32 s59, s50, 3
  s_lshr_b32 s60, s50, 2
  s_and_b32 s60, s60, 1
  s_and_b32 s61, s50, 3
  s_lshl_b32 s62, s59, 4
  s_lshl_b32 s63, s60, 10
  s_add_u32 s62, s62, s63
  s_lshl_b32 s63, s61, 8
  s_add_u32 s62, s62, s63
  s_lshl_b32 s63, s59, 11
  s_lshl_b32 s64, s60, 10
  s_add_u32 s63, s63, s64
  s_lshl_b32 s64, s61, 8
  s_add_u32 s63, s63, s64
  s_cmp_lg_u32 s3, 3
  s_cbranch_scc1 L_a_r3
  v_lshrrev_b32 v7, 2, v0
  v_mul_u32_u24 v7, 514, v7
  v_and_b32 v6, 3, v0
  v_lshl_add_u32 v7, v6, 4, v7
  s_mul_i32 s64, s62, 514
  s_lshl_b32 s65, s49, 6
  s_add_u32 s64, s64, s65
  buffer_load_dwordx4 v[8:11], v7, s[12:15], s64 offen
  buffer_load_dwordx4 v[24:27], v7, s[16:19], s64 offen
  s_add_u32 s64, s64, 32896
  buffer_load_dwordx4 v[12:15], v7, s[12:15], s64 offen
  buffer_load_dwordx4 v[28:31], v7, s[16:19], s64 offen
  s_add_u32 s64, s64, 32896
  buffer_load_dwordx4 v[16:19], v7, s[12:15], s64 offen
  buffer_load_dwordx4 v[32:35], v7, s[16:19], s64 offen
  s_add_u32 s64, s64, 32896
  buffer_load_dwordx4 v[20:23], v7, s[12:15], s64 offen
  buffer_load_dwordx4 v[36:39], v7, s[16:19], s64 offen
L_a_r3:
  s_lshl_b32 s65, s49, 2
  s_xor_b32 s66, s3, 2
  s_or_b32 s66, s66, s65
  s_cmp_lg_u32 s66, 0
  s_cbranch_scc1 L_a_r2
  v_lshlrev_b32 v48, 6, v2
  v_add_u32 v48, v48, v1
  v_add_u32 v48, s62, v48
  v_sub_u32 v49, 2048, v48
  v_and_b32 v49, 2047, v49
  v_mul_u32_u24 v48, 514, v48
  v_mul_u32_u24 v49, 514, v49
  buffer_load_ushort v40, v48, s[12:15], 0 offen offset:0
  buffer_load_ushort v41, v48, s[12:15], 0 offen offset:512
  buffer_load_ushort v42, v49, s[12:15], 0 offen offset:0
  buffer_load_ushort v43, v49, s[12:15], 0 offen offset:512
  buffer_load_ushort v44, v48, s[16:19], 0 offen offset:0
  buffer_load_ushort v45, v48, s[16:19], 0 offen offset:512
  buffer_load_ushort v46, v49, s[16:19], 0 offen offset:0
  buffer_load_ushort v47, v49, s[16:19], 0 offen offset:512
L_a_r2:
  s_cmp_eq_u32 s3, 3
  s_cbranch_scc1 L_wr306_3
  s_cmp_eq_u32 s66, 0
  s_cbranch_scc1 L_wr306_2
  s_waitcnt vmcnt(16)
  s_branch L_wr306_e
L_wr306_3:
  s_waitcnt vmcnt(24)
  s_branch L_wr306_e
L_wr306_2:
  s_waitcnt vmcnt(24)
L_wr306_e:
  s_barrier
  s_add_u32 m0, s53, 95232
  s_add_u32 s55, s51, 384
  buffer_load_dwordx4 v4, s[8:11], s55 offen lds
  s_add_u32 m0, s53, 99328
  s_add_u32 s55, s51, 33152
  buffer_load_dwordx4 v4, s[8:11], s55 offen lds
  s_add_u32 m0, s53, 103424
  s_add_u32 s55, s51, 65920
  buffer_load_dwordx4 v4, s[8:11], s55 offen lds
  s_add_u32 m0, s53, 107520
  s_add_u32 s55, s51, 98688
  buffer_load_dwordx4 v4, s[8:11], s55 offen lds
  s_add_u32 m0, s54, 95232
  s_add_u32 s55, s52, 688128
  s_mov_b32 exec_hi, 0x00ffffff
  buffer_load_dwordx4 v5, s[20:23], s55 offen lds
  s_mov_b32 exec_hi, -1
  s_add_u32 m0, s54, 99072
  s_add_u32 s55, s52, 745472
  s_mov_b32 exec_hi, 0x00ffffff
  buffer_load_dwordx4 v5, s[20:23], s55 offen lds
  s_mov_b32 exec_hi, -1
  s_add_u32 m0, s54, 102912
  s_add_u32 s55, s52, 802816
  s_mov_b32 exec_hi, 0x00ffffff
  buffer_load_dwordx4 v5, s[20:23], s55 offen lds
  s_mov_b32 exec_hi, -1
  s_add_u32 m0, s54, 106752
  s_add_u32 s55, s52, 860160
  s_mov_b32 exec_hi, 0x00ffffff
  buffer_load_dwordx4 v5, s[20:23], s55 offen lds
  s_mov_b32 exec_hi, -1
  s_cmp_eq_u32 s3, 3
  s_cbranch_scc1 L_wr351_3
  s_cmp_eq_u32 s66, 0
  s_cbranch_scc1 L_wr351_2
  s_waitcnt vmcnt(16)
  s_branch L_wr351_e
L_wr351_3:
  s_waitcnt vmcnt(24)
  s_branch L_wr351_e
L_wr351_2:
  s_waitcnt vmcnt(24)
L_wr351_e:
  s_barrier
  s_add_u32 m0, s53, 126976
  s_add_u32 s55, s51, 512
  buffer_load_dwordx4 v4, s[8:11], s55 offen lds
  s_add_u32 m0, s53, 131072
  s_add_u32 s55, s51, 33280
  buffer_load_dwordx4 v4, s[8:11], s55 offen lds
  s_add_u32 m0, s53, 135168
  s_add_u32 s55, s51, 66048
  buffer_load_dwordx4 v4, s[8:11], s55 offen lds
  s_add_u32 m0, s53, 139264
  s_add_u32 s55, s51, 98816
  buffer_load_dwordx4 v4, s[8:11], s55 offen lds
  s_add_u32 m0, s54, 126976
  s_add_u32 s55, s52, 917504
  s_mov_b32 exec_hi, 0x00ffffff
  buffer_load_dwordx4 v5, s[20:23], s55 offen lds
  s_mov_b32 exec_hi, -1
  s_add_u32 m0, s54, 130816
  s_add_u32 s55, s52, 974848
  s_mov_b32 exec_hi, 0x00ffffff
  buffer_load_dwordx4 v5, s[20:23], s55 offen lds
  s_mov_b32 exec_hi, -1
  s_add_u32 m0, s54, 134656
  s_add_u32 s55, s52, 1032192
  s_mov_b32 exec_hi, 0x00ffffff
  buffer_load_dwordx4 v5, s[20:23], s55 offen lds
  s_mov_b32 exec_hi, -1
  s_add_u32 m0, s54, 138496
  s_add_u32 s55, s52, 1089536
  s_mov_b32 exec_hi, 0x00ffffff
  buffer_load_dwordx4 v5, s[20:23], s55 offen lds
  s_mov_b32 exec_hi, -1
  s_cmp_lg_u32 s3, 3
  s_cbranch_scc1 L_a_w3
  s_waitcnt vmcnt(16)
  s_mov_b32 s78, 0x05040100
  s_mov_b32 s79, 0x07060302
  v_perm_b32 v188, v24, v8, s78
  v_perm_b32 v189, v28, v12, s78
  v_perm_b32 v190, v32, v16, s78
  v_perm_b32 v191, v36, v20, s78
  v_perm_b32 v192, v24, v8, s79
  v_perm_b32 v193, v28, v12, s79
  v_perm_b32 v194, v32, v16, s79
  v_perm_b32 v195, v36, v20, s79
  v_perm_b32 v196, v25, v9, s78
  v_perm_b32 v197, v29, v13, s78
  v_perm_b32 v198, v33, v17, s78
  v_perm_b32 v199, v37, v21, s78
  v_perm_b32 v200, v25, v9, s79
  v_perm_b32 v201, v29, v13, s79
  v_perm_b32 v202, v33, v17, s79
  v_perm_b32 v203, v37, v21, s79
  v_perm_b32 v204, v26, v10, s78
  v_perm_b32 v205, v30, v14, s78
  v_perm_b32 v206, v34, v18, s78
  v_perm_b32 v207, v38, v22, s78
  v_perm_b32 v208, v26, v10, s79
  v_perm_b32 v209, v30, v14, s79
  v_perm_b32 v210, v34, v18, s79
  v_perm_b32 v211, v38, v22, s79
  v_perm_b32 v212, v27, v11, s78
  v_perm_b32 v213, v31, v15, s78
  v_perm_b32 v214, v35, v19, s78
  v_perm_b32 v215, v39, v23, s78
  v_perm_b32 v216, v27, v11, s79
  v_perm_b32 v217, v31, v15, s79
  v_perm_b32 v218, v35, v19, s79
  v_perm_b32 v219, v39, v23, s79
  v_and_b32 v96, 3, v0
  v_lshlrev_b32 v97, 16, v96
  v_lshrrev_b32 v98, 2, v0
  v_lshl_add_u32 v97, v98, 4, v97
  s_lshl_b32 s76, s49, 2
  v_add_u32 v96, s76, v96
  v_cmp_eq_u32 vcc, 0, v96
  v_mov_b32 v98, 1073741824
  s_nop 0
  v_cndmask_b32 v98, v97, v98, vcc
  s_lshl_b32 s76, s49, 18
  s_add_u32 s76, s76, s63
  s_add_u32 s76, s76, 2097152
  buffer_store_dwordx4 v[188:191], v98, s[40:43], s76 offen sc1
  s_add_u32 s76, s76, 8192
  buffer_store_dwordx4 v[192:195], v97, s[40:43], s76 offen sc1
  s_add_u32 s76, s76, 8192
  buffer_store_dwordx4 v[196:199], v97, s[40:43], s76 offen sc1
  s_add_u32 s76, s76, 8192
  buffer_store_dwordx4 v[200:203], v97, s[40:43], s76 offen sc1
  s_add_u32 s76, s76, 8192
  buffer_store_dwordx4 v[204:207], v97, s[40:43], s76 offen sc1
  s_add_u32 s76, s76, 8192
  buffer_store_dwordx4 v[208:211], v97, s[40:43], s76 offen sc1
  s_add_u32 s76, s76, 8192
  buffer_store_dwordx4 v[212:215], v97, s[40:43], s76 offen sc1
  s_add_u32 s76, s76, 8192
  buffer_store_dwordx4 v[216:219], v97, s[40:43], s76 offen sc1
L_a_w3:
  s_cmp_lg_u32 s66, 0
  s_cbranch_scc1 L_a_w2
  s_waitcnt vmcnt(16)
  v_lshlrev_b32 v40, 16, v40
  v_lshlrev_b32 v41, 16, v41
  v_lshlrev_b32 v42, 16, v42
  v_lshlrev_b32 v43, 16, v43
  v_lshlrev_b32 v44, 16, v44
  v_lshlrev_b32 v45, 16, v45
  v_lshlrev_b32 v46, 16, v46
  v_lshlrev_b32 v47, 16, v47
  v_add_f32 v68, v40, v42
  v_add_f32 v69, v41, v43
  v_sub_f32 v70, v44, v46
  v_sub_f32 v71, v45, v47
  v_add_f32 v72, v68, v69
  v_add_f32 v73, v70, v71
  v_sub_f32 v74, v68, v69
  v_sub_f32 v75, v70, v71
  v_mul_f32 v72, 0x3e800000, v72
  v_mul_f32 v73, 0x3e800000, v73
  v_mul_f32 v74, 0x3e800000, v74
  v_mul_f32 v75, 0x3e800000, v75
  v_cvt_pk_bf16_f32 v68, v72, v73
  v_cvt_pk_bf16_f32 v69, v74, v75
  v_lshlrev_b32 v70, 4, v1
  v_lshl_add_u32 v70, v2, 2, v70
  s_add_u32 s77, s63, 4194304
  s_add_u32 s76, s63, 2097152
  buffer_store_dword v68, v70, s[40:43], s76 offen sc1
  buffer_store_dword v69, v70, s[40:43], s77 offen sc1
L_a_w2:
  s_cmp_eq_u32 s3, 3
  s_cbranch_scc1 L_wr493_3
  s_cmp_eq_u32 s66, 0
  s_cbranch_scc1 L_wr493_2
  s_waitcnt vmcnt(16)
  s_branch L_wr493_e
L_wr493_3:
  s_waitcnt vmcnt(32)
  s_branch L_wr493_e
L_wr493_2:
  s_waitcnt vmcnt(26)
L_wr493_e:
  s_barrier
  s_add_u32 m0, s53, 0
  s_add_u32 s55, s51, 640
  buffer_load_dwordx4 v4, s[8:11], s55 offen lds
  s_add_u32 m0, s53, 4096
  s_add_u32 s55, s51, 33408
  buffer_load_dwordx4 v4, s[8:11], s55 offen lds
  s_add_u32 m0, s53, 8192
  s_add_u32 s55, s51, 66176
  buffer_load_dwordx4 v4, s[8:11], s55 offen lds
  s_add_u32 m0, s53, 12288
  s_add_u32 s55, s51, 98944
  buffer_load_dwordx4 v4, s[8:11], s55 offen lds
  s_add_u32 m0, s54, 0
  s_add_u32 s55, s52, 1146880
  s_mov_b32 exec_hi, 0x00ffffff
  buffer_load_dwordx4 v5, s[20:23], s55 offen lds
  s_mov_b32 exec_hi, -1
  s_add_u32 m0, s54, 3840
  s_add_u32 s55, s52, 1204224
  s_mov_b32 exec_hi, 0x00ffffff
  buffer_load_dwordx4 v5, s[20:23], s55 offen lds
  s_mov_b32 exec_hi, -1
  s_add_u32 m0, s54, 7680
  s_add_u32 s55, s52, 1261568
  s_mov_b32 exec_hi, 0x00ffffff
  buffer_load_dwordx4 v5, s[20:23], s55 offen lds
  s_mov_b32 exec_hi, -1
  s_add_u32 m0, s54, 11520
  s_add_u32 s55, s52, 1318912
  s_mov_b32 exec_hi, 0x00ffffff
  buffer_load_dwordx4 v5, s[20:23], s55 offen lds
  s_mov_b32 exec_hi, -1
  s_cmp_eq_u32 s3, 3
  s_cbranch_scc1 L_wr538_3
  s_cmp_eq_u32 s66, 0
  s_cbranch_scc1 L_wr538_2
  s_waitcnt vmcnt(16)
  s_branch L_wr538_e
L_wr538_3:
  s_waitcnt vmcnt(24)
  s_branch L_wr538_e
L_wr538_2:
  s_waitcnt vmcnt(18)
L_wr538_e:
  s_barrier
  s_add_u32 m0, s53, 31744
  s_add_u32 s55, s51, 768
  buffer_load_dwordx4 v4, s[8:11], s55 offen lds
  s_add_u32 m0, s53, 35840
  s_add_u32 s55, s51, 33536
  buffer_load_dwordx4 v4, s[8:11], s55 offen lds
  s_add_u32 m0, s53, 39936
  s_add_u32 s55, s51, 66304
  buffer_load_dwordx4 v4, s[8:11], s55 offen lds
  s_add_u32 m0, s53, 44032
  s_add_u32 s55, s51, 99072
  buffer_load_dwordx4 v4, s[8:11], s55 offen lds
  s_add_u32 m0, s54, 31744
  s_add_u32 s55, s52, 1376256
  s_mov_b32 exec_hi, 0x00ffffff
  buffer_load_dwordx4 v5, s[20:23], s55 offen lds
  s_mov_b32 exec_hi, -1
  s_add_u32 m0, s54, 35584
  s_add_u32 s55, s52, 1433600
  s_mov_b32 exec_hi, 0x00ffffff
  buffer_load_dwordx4 v5, s[20:23], s55 offen lds
  s_mov_b32 exec_hi, -1
  s_add_u32 m0, s54, 39424
  s_add_u32 s55, s52, 1490944
  s_mov_b32 exec_hi, 0x00ffffff
  buffer_load_dwordx4 v5, s[20:23], s55 offen lds
  s_mov_b32 exec_hi, -1
  s_add_u32 m0, s54, 43264
  s_add_u32 s55, s52, 1548288
  s_mov_b32 exec_hi, 0x00ffffff
  buffer_load_dwordx4 v5, s[20:23], s55 offen lds
  s_mov_b32 exec_hi, -1
  s_cmp_eq_u32 s3, 3
  s_cbranch_scc1 L_wr583_3
  s_cmp_eq_u32 s66, 0
  s_cbranch_scc1 L_wr583_2
  s_waitcnt vmcnt(16)
  s_branch L_wr583_e
L_wr583_3:
  s_waitcnt vmcnt(24)
  s_branch L_wr583_e
L_wr583_2:
  s_waitcnt vmcnt(18)
L_wr583_e:
  s_barrier
  s_add_u32 m0, s53, 63488
  s_add_u32 s55, s51, 896
  buffer_load_dwordx4 v4, s[8:11], s55 offen lds
  s_add_u32 m0, s53, 67584
  s_add_u32 s55, s51, 33664
  buffer_load_dwordx4 v4, s[8:11], s55 offen lds
  s_add_u32 m0, s53, 71680
  s_add_u32 s55, s51, 66432
  buffer_load_dwordx4 v4, s[8:11], s55 offen lds
  s_add_u32 m0, s53, 75776
  s_add_u32 s55, s51, 99200
  buffer_load_dwordx4 v4, s[8:11], s55 offen lds
  s_add_u32 m0, s54, 63488
  s_add_u32 s55, s52, 1605632
  s_mov_b32 exec_hi, 0x00ffffff
  buffer_load_dwordx4 v5, s[20:23], s55 offen lds
  s_mov_b32 exec_hi, -1
  s_add_u32 m0, s54, 67328
  s_add_u32 s55, s52, 1662976
  s_mov_b32 exec_hi, 0x00ffffff
  buffer_load_dwordx4 v5, s[20:23], s55 offen lds
  s_mov_b32 exec_hi, -1
  s_add_u32 m0, s54, 71168
  s_add_u32 s55, s52, 1720320
  s_mov_b32 exec_hi, 0x00ffffff
  buffer_load_dwordx4 v5, s[20:23], s55 offen lds
  s_mov_b32 exec_hi, -1
  s_add_u32 m0, s54, 75008
  s_add_u32 s55, s52, 1777664
  s_mov_b32 exec_hi, 0x00ffffff
  buffer_load_dwordx4 v5, s[20:23], s55 offen lds
  s_mov_b32 exec_hi, -1
  s_waitcnt vmcnt(16)
  s_barrier
  s_lshl_b32 s67, s4, 2
  s_lshr_b32 s68, s5, 3
  s_add_u32 s67, s67, s68
  s_and_b32 s68, s5, 7
  s_mul_i32 s69, s67, 229376
  s_mul_i32 s70, s3, 57344
  s_add_u32 s69, s69, s70
  s_add_u32 s69, s69, 8388608
  s_mul_i32 s70, s3, 458752
  s_lshl_b32 s71, s68, 7
  s_add_u32 s70, s70, s71
  s_lshl_b32 s71, s3, 15
  s_lshr_b32 s72, s67, 1
  s_and_b32 s73, s67, 1
  s_lshr_b32 s74, s72, 2
  s_lshl_b32 s74, s74, 11
  s_lshl_b32 s75, s73, 10
  s_add_u32 s74, s74, s75
  s_and_b32 s75, s72, 3
  s_lshl_b32 s75, s75, 8
  s_add_u32 s74, s74, s75
  v_lshrrev_b32 v244, 3, v0
  v_lshlrev_b32 v246, 10, v244
  v_lshrrev_b32 v244, 1, v244
  v_and_b32 v244, 3, v244
  v_bfe_u32 v245, v0, 1, 2
  v_xor_b32 v244, v244, v245
  v_lshlrev_b32 v244, 1, v244
  v_and_b32 v245, 1, v0
  v_add_u32 v244, v244, v245
  v_lshl_add_u32 v246, v244, 4, v246
  s_waitcnt vmcnt(8)
  s_barrier
  s_waitcnt vmcnt(0)
  s_barrier
  s_and_b32 s92, s5, 3
  s_lshl_b32 s92, s92, 6
  s_cmp_lg_u32 s3, 0
  s_cbranch_scc1 L_ss667
  s_atomic_add s90, s[44:45], s92
L_ss667:
  s_barrier
  s_add_u32 m0, s71, 0
  s_add_u32 s55, s70, 0
  buffer_load_dwordx4 v246, s[28:31], s55 offen lds
  s_add_u32 m0, s71, 1024
  s_add_u32 s55, s70, 8192
  buffer_load_dwordx4 v246, s[28:31], s55 offen lds
  s_add_u32 m0, s71, 2048
  s_add_u32 s55, s70, 16384
  buffer_load_dwordx4 v246, s[28:31], s55 offen lds
  s_add_u32 m0, s71, 3072
  s_add_u32 s55, s70, 24576
  buffer_load_dwordx4 v246, s[28:31], s55 offen lds
  s_add_u32 m0, s71, 4096
  s_add_u32 s55, s70, 32768
  buffer_load_dwordx4 v246, s[28:31], s55 offen lds
  s_add_u32 m0, s71, 5120
  s_add_u32 s55, s70, 40960
  buffer_load_dwordx4 v246, s[28:31], s55 offen lds
  s_add_u32 m0, s71, 6144
  s_add_u32 s55, s70, 49152
  buffer_load_dwordx4 v246, s[28:31], s55 offen lds
  s_add_u32 m0, s71, 7168
  s_add_u32 s55, s70, 57344
  buffer_load_dwordx4 v246, s[28:31], s55 offen lds
  s_add_u32 m0, s71, 8192
  s_add_u32 s55, s70, 65536
  buffer_load_dwordx4 v246, s[28:31], s55 offen lds
  s_add_u32 m0, s71, 9216
  s_add_u32 s55, s70, 73728
  buffer_load_dwordx4 v246, s[28:31], s55 offen lds
  s_add_u32 m0, s71, 10240
  s_add_u32 s55, s70, 81920
  buffer_load_dwordx4 v246, s[28:31], s55 offen lds
  s_add_u32 m0, s71, 11264
  s_add_u32 s55, s70, 90112
  buffer_load_dwordx4 v246, s[28:31], s55 offen lds
  s_add_u32 m0, s71, 12288
  s_add_u32 s55, s70, 98304
  buffer_load_dwordx4 v246, s[28:31], s55 offen lds
  s_add_u32 m0, s71, 13312
  s_add_u32 s55, s70, 106496
  buffer_load_dwordx4 v246, s[28:31], s55 offen lds
  s_add_u32 m0, s71, 14336
  s_add_u32 s55, s70, 114688
  buffer_load_dwordx4 v246, s[28:31], s55 offen lds
  s_add_u32 m0, s71, 15360
  s_add_u32 s55, s70, 122880
  buffer_load_dwordx4 v246, s[28:31], s55 offen lds
  s_add_u32 m0, s71, 16384
  s_add_u32 s55, s70, 131072
  buffer_load_dwordx4 v246, s[28:31], s55 offen lds
  s_add_u32 m0, s71, 17408
  s_add_u32 s55, s70, 139264
  buffer_load_dwordx4 v246, s[28:31], s55 offen lds
  s_add_u32 m0, s71, 18432
  s_add_u32 s55, s70, 147456
  buffer_load_dwordx4 v246, s[28:31], s55 offen lds
  s_add_u32 m0, s71, 19456
  s_add_u32 s55, s70, 155648
  buffer_load_dwordx4 v246, s[28:31], s55 offen lds
  s_cmp_lg_u32 s3, 0
  s_cbranch_scc1 L_f_s1
  s_waitcnt vmcnt(0)
  s_mov_b32 s93, 0
  v_mul_u32_u24 v251, 64, v0
  s_mov_b64 exec, 0xf
  s_mov_b32 s94, 0
L_poll736:
  buffer_load_dword v250, v251, s[44:47], s93 offen sc1
  s_add_u32 s94, s94, 1
  s_waitcnt vmcnt(0)
  v_cmp_gt_u32 vcc, 64, v250
  s_nop 4
  s_cbranch_vccz L_poll736_done
  s_cmp_gt_u32 s94, 50000
  s_cbranch_scc1 L_poll736_done
  s_sleep 16
  s_branch L_poll736
L_poll736_done:
  s_mov_b64 exec, -1
  s_lshl_b32 s56, s4, 5
  s_add_u32 s56, s56, s5
  v_lshrrev_b32 v64, 5, v0
  v_lshlrev_b32 v64, 18, v64
  v_bfe_u32 v65, v0, 1, 4
  v_lshl_add_u32 v64, v65, 13, v64
  v_and_b32 v65, 1, v0
  v_lshl_add_u32 v64, v65, 4, v64
  s_lshl_b32 s57, s56, 5
  s_add_u32 s57, s57, 0
  s_mov_b32 m0, 131072
  s_add_u32 s58, s57, 0
  buffer_load_dwordx4 v64, s[40:43], s58 offen sc1 lds
  s_mov_b32 m0, 132096
  s_add_u32 s58, s57, 131072
  buffer_load_dwordx4 v64, s[40:43], s58 offen sc1 lds
  s_mov_b32 m0, 133120
  s_add_u32 s58, s57, 524288
  buffer_load_dwordx4 v64, s[40:43], s58 offen sc1 lds
  s_mov_b32 m0, 134144
  s_add_u32 s58, s57, 655360
  buffer_load_dwordx4 v64, s[40:43], s58 offen sc1 lds
  s_mov_b32 m0, 135168
  s_add_u32 s58, s57, 1048576
  buffer_load_dwordx4 v64, s[40:43], s58 offen sc1 lds
  s_mov_b32 m0, 136192
  s_add_u32 s58, s57, 1179648
  buffer_load_dwordx4 v64, s[40:43], s58 offen sc1 lds
  s_mov_b32 m0, 137216
  s_add_u32 s58, s57, 1572864
  buffer_load_dwordx4 v64, s[40:43], s58 offen sc1 lds
  s_mov_b32 m0, 138240
  s_add_u32 s58, s57, 1703936
  buffer_load_dwordx4 v64, s[40:43], s58 offen sc1 lds
  s_lshl_b32 s57, s56, 13
  s_add_u32 s57, s57, 2097152
  s_mov_b32 m0, 155648
  s_add_u32 s58, s57, 0
  buffer_load_dwordx4 v3, s[40:43], s58 offen sc1 lds
  s_mov_b32 m0, 156672
  s_add_u32 s58, s57, 1024
  buffer_load_dwordx4 v3, s[40:43], s58 offen sc1 lds
  s_mov_b32 m0, 157696
  s_add_u32 s58, s57, 2048
  buffer_load_dwordx4 v3, s[40:43], s58 offen sc1 lds
  s_mov_b32 m0, 158720
  s_add_u32 s58, s57, 3072
  buffer_load_dwordx4 v3, s[40:43], s58 offen sc1 lds
  s_mov_b32 m0, 159744
  s_add_u32 s58, s57, 4096
  buffer_load_dwordx4 v3, s[40:43], s58 offen sc1 lds
  s_mov_b32 m0, 160768
  s_add_u32 s58, s57, 5120
  buffer_load_dwordx4 v3, s[40:43], s58 offen sc1 lds
  s_mov_b32 m0, 161792
  s_add_u32 s58, s57, 6144
  buffer_load_dwordx4 v3, s[40:43], s58 offen sc1 lds
  s_mov_b32 m0, 162816
  s_add_u32 s58, s57, 7168
  buffer_load_dwordx4 v3, s[40:43], s58 offen sc1 lds
L_f_s1:
  s_waitcnt vmcnt(0)
  s_barrier
  s_lshl_b32 s92, s6, 7
  s_add_u32 s92, s92, 4210688
  s_cmp_lg_u32 s3, 0
  s_cbranch_scc1 L_ss816
  s_atomic_add s90, s[40:41], s92
L_ss816:
  s_add_u32 m0, s71, 20480
  s_add_u32 s55, s70, 163840
  buffer_load_dwordx4 v246, s[28:31], s55 offen lds
  s_add_u32 m0, s71, 21504
  s_add_u32 s55, s70, 172032
  buffer_load_dwordx4 v246, s[28:31], s55 offen lds
  s_add_u32 m0, s71, 22528
  s_add_u32 s55, s70, 180224
  buffer_load_dwordx4 v246, s[28:31], s55 offen lds
  s_add_u32 m0, s71, 23552
  s_add_u32 s55, s70, 188416
  buffer_load_dwordx4 v246, s[28:31], s55 offen lds
  s_add_u32 m0, s71, 24576
  s_add_u32 s55, s70, 196608
  buffer_load_dwordx4 v246, s[28:31], s55 offen lds
  s_add_u32 m0, s71, 25600
  s_add_u32 s55, s70, 204800
  buffer_load_dwordx4 v246, s[28:31], s55 offen lds
  s_add_u32 m0, s71, 26624
  s_add_u32 s55, s70, 212992
  buffer_load_dwordx4 v246, s[28:31], s55 offen lds
  s_add_u32 m0, s71, 27648
  s_add_u32 s55, s70, 221184
  buffer_load_dwordx4 v246, s[28:31], s55 offen lds
  s_add_u32 m0, s71, 28672
  s_add_u32 s55, s70, 229376
  buffer_load_dwordx4 v246, s[28:31], s55 offen lds
  s_add_u32 m0, s71, 29696
  s_add_u32 s55, s70, 237568
  buffer_load_dwordx4 v246, s[28:31], s55 offen lds
  s_add_u32 m0, s71, 30720
  s_add_u32 s55, s70, 245760
  buffer_load_dwordx4 v246, s[28:31], s55 offen lds
  s_add_u32 m0, s71, 31744
  s_add_u32 s55, s70, 253952
  buffer_load_dwordx4 v246, s[28:31], s55 offen lds
  s_waitcnt vmcnt(0)
  s_barrier
  s_lshl_b32 s56, s4, 5
  s_add_u32 s56, s56, s5
  s_cmp_lg_u32 s56, 0
  s_cbranch_scc1 L_f_nospec
  s_barrier
L_f_nospec:
  s_lshl_b32 s93, s72, 7
  s_add_u32 s93, s93, 4210688
  s_cmp_lg_u32 s3, 0
  s_cbranch_scc1 L_pw866
  v_mul_u32_u24 v251, 0, v0
  s_mov_b64 exec, 0x1
  s_mov_b32 s94, 0
L_poll868:
  buffer_load_dword v250, v251, s[40:43], s93 offen sc1
  s_add_u32 s94, s94, 1
  s_waitcnt vmcnt(0)
  v_cmp_gt_u32 vcc, 16, v250
  s_nop 4
  s_cbranch_vccz L_poll868_done
  s_cmp_gt_u32 s94, 50000
  s_cbranch_scc1 L_poll868_done
  s_sleep 16
  s_branch L_poll868
L_poll868_done:
  s_mov_b64 exec, -1
L_pw866:
  s_barrier
  s_barrier
  s_and_b32 s92, s2, 7
  s_lshl_b32 s92, s92, 7
  s_add_u32 s92, s92, 4212736
  s_cmp_lg_u32 s3, 0
  s_cbranch_scc1 L_ss889
  s_atomic_add s90, s[40:41], s92
L_ss889:
  s_lshl_b32 s75, s68, 6
  v_add_u32 v80, s75, v1
  v_cvt_f32_u32 v80, v80
  s_lshl_b32 s75, s3, 6
  v_lshlrev_b32 v81, 2, v2
  v_add_u32 v81, s75, v81
  v_cvt_f32_u32 v81, v81
  v_mov_b32 v82, v80
  v_mul_f32 v82, 0x3b000000, v82
  v_mul_f32 v86, v81, v82
  v_add_f32 v83, 0x41800000, v80
  v_mul_f32 v83, 0x3b000000, v83
  v_mul_f32 v87, v81, v83
  v_add_f32 v84, 0x42000000, v80
  v_mul_f32 v84, 0x3b000000, v84
  v_mul_f32 v88, v81, v84
  v_add_f32 v85, 0x42400000, v80
  v_mul_f32 v85, 0x3b000000, v85
  v_mul_f32 v89, v81, v85
  v_fmamk_f32 v93, v82, 0x3f800000, v86
  v_fmamk_f32 v94, v82, 0x40000000, v86
  v_fmamk_f32 v95, v82, 0x40400000, v86
  v_cos_f32 v96, v86
  v_sin_f32 v100, v86
  v_cos_f32 v97, v93
  v_sin_f32 v101, v93
  v_cos_f32 v98, v94
  v_sin_f32 v102, v94
  v_cos_f32 v99, v95
  v_sin_f32 v103, v95
  v_cvt_pk_bf16_f32 v8, v96, v100
  v_cvt_pk_bf16_f32 v9, v97, v101
  v_cvt_pk_bf16_f32 v10, v98, v102
  v_cvt_pk_bf16_f32 v11, v99, v103
  v_fmamk_f32 v93, v83, 0x3f800000, v87
  v_fmamk_f32 v94, v83, 0x40000000, v87
  v_fmamk_f32 v95, v83, 0x40400000, v87
  v_cos_f32 v96, v87
  v_sin_f32 v100, v87
  v_cos_f32 v97, v93
  v_sin_f32 v101, v93
  v_cos_f32 v98, v94
  v_sin_f32 v102, v94
  v_cos_f32 v99, v95
  v_sin_f32 v103, v95
  v_cvt_pk_bf16_f32 v12, v96, v100
  v_cvt_pk_bf16_f32 v13, v97, v101
  v_cvt_pk_bf16_f32 v14, v98, v102
  v_cvt_pk_bf16_f32 v15, v99, v103
  v_fmamk_f32 v93, v84, 0x3f800000, v88
  v_fmamk_f32 v94, v84, 0x40000000, v88
  v_fmamk_f32 v95, v84, 0x40400000, v88
  v_cos_f32 v96, v88
  v_sin_f32 v100, v88
  v_cos_f32 v97, v93
  v_sin_f32 v101, v93
  v_cos_f32 v98, v94
  v_sin_f32 v102, v94
  v_cos_f32 v99, v95
  v_sin_f32 v103, v95
  v_cvt_pk_bf16_f32 v16, v96, v100
  v_cvt_pk_bf16_f32 v17, v97, v101
  v_cvt_pk_bf16_f32 v18, v98, v102
  v_cvt_pk_bf16_f32 v19, v99, v103
  v_fmamk_f32 v93, v85, 0x3f800000, v89
  v_fmamk_f32 v94, v85, 0x40000000, v89
  v_fmamk_f32 v95, v85, 0x40400000, v89
  v_cos_f32 v96, v89
  v_sin_f32 v100, v89
  v_cos_f32 v97, v93
  v_sin_f32 v101, v93
  v_cos_f32 v98, v94
  v_sin_f32 v102, v94
  v_cos_f32 v99, v95
  v_sin_f32 v103, v95
  v_cvt_pk_bf16_f32 v20, v96, v100
  v_cvt_pk_bf16_f32 v21, v97, v101
  v_cvt_pk_bf16_f32 v22, v98, v102
  v_cvt_pk_bf16_f32 v23, v99, v103
  v_fmamk_f32 v92, v82, 0x41800000, v86
  v_fmamk_f32 v93, v82, 0x41880000, v86
  v_fmamk_f32 v94, v82, 0x41900000, v86
  v_fmamk_f32 v95, v82, 0x41980000, v86
  v_cos_f32 v96, v92
  v_sin_f32 v100, v92
  v_cos_f32 v97, v93
  v_sin_f32 v101, v93
  v_cos_f32 v98, v94
  v_sin_f32 v102, v94
  v_cos_f32 v99, v95
  v_sin_f32 v103, v95
  v_cvt_pk_bf16_f32 v24, v96, v100
  v_cvt_pk_bf16_f32 v25, v97, v101
  v_cvt_pk_bf16_f32 v26, v98, v102
  v_cvt_pk_bf16_f32 v27, v99, v103
  v_fmamk_f32 v92, v83, 0x41800000, v87
  v_fmamk_f32 v93, v83, 0x41880000, v87
  v_fmamk_f32 v94, v83, 0x41900000, v87
  v_fmamk_f32 v95, v83, 0x41980000, v87
  v_cos_f32 v96, v92
  v_sin_f32 v100, v92
  v_cos_f32 v97, v93
  v_sin_f32 v101, v93
  v_cos_f32 v98, v94
  v_sin_f32 v102, v94
  v_cos_f32 v99, v95
  v_sin_f32 v103, v95
  v_cvt_pk_bf16_f32 v28, v96, v100
  v_cvt_pk_bf16_f32 v29, v97, v101
  v_cvt_pk_bf16_f32 v30, v98, v102
  v_cvt_pk_bf16_f32 v31, v99, v103
  v_fmamk_f32 v92, v84, 0x41800000, v88
  v_fmamk_f32 v93, v84, 0x41880000, v88
  v_fmamk_f32 v94, v84, 0x41900000, v88
  v_fmamk_f32 v95, v84, 0x41980000, v88
  v_cos_f32 v96, v92
  v_sin_f32 v100, v92
  v_cos_f32 v97, v93
  v_sin_f32 v101, v93
  v_cos_f32 v98, v94
  v_sin_f32 v102, v94
  v_cos_f32 v99, v95
  v_sin_f32 v103, v95
  v_cvt_pk_bf16_f32 v32, v96, v100
  v_cvt_pk_bf16_f32 v33, v97, v101
  v_cvt_pk_bf16_f32 v34, v98, v102
  v_cvt_pk_bf16_f32 v35, v99, v103
  v_fmamk_f32 v92, v85, 0x41800000, v89
  v_fmamk_f32 v93, v85, 0x41880000, v89
  v_fmamk_f32 v94, v85, 0x41900000, v89
  v_fmamk_f32 v95, v85, 0x41980000, v89
  v_cos_f32 v96, v92
  v_sin_f32 v100, v92
  v_cos_f32 v97, v93
  v_sin_f32 v101, v93
  v_cos_f32 v98, v94
  v_sin_f32 v102, v94
  v_cos_f32 v99, v95
  v_sin_f32 v103, v95
  v_cvt_pk_bf16_f32 v36, v96, v100
  v_cvt_pk_bf16_f32 v37, v97, v101
  v_cvt_pk_bf16_f32 v38, v98, v102
  v_cvt_pk_bf16_f32 v39, v99, v103
  v_fmamk_f32 v92, v82, 0x42000000, v86
  v_fmamk_f32 v93, v82, 0x42040000, v86
  v_fmamk_f32 v94, v82, 0x42080000, v86
  v_fmamk_f32 v95, v82, 0x420c0000, v86
  v_cos_f32 v96, v92
  v_sin_f32 v100, v92
  v_cos_f32 v97, v93
  v_sin_f32 v101, v93
  v_cos_f32 v98, v94
  v_sin_f32 v102, v94
  v_cos_f32 v99, v95
  v_sin_f32 v103, v95
  v_cvt_pk_bf16_f32 v40, v96, v100
  v_cvt_pk_bf16_f32 v41, v97, v101
  v_cvt_pk_bf16_f32 v42, v98, v102
  v_cvt_pk_bf16_f32 v43, v99, v103
  v_fmamk_f32 v92, v83, 0x42000000, v87
  v_fmamk_f32 v93, v83, 0x42040000, v87
  v_fmamk_f32 v94, v83, 0x42080000, v87
  v_fmamk_f32 v95, v83, 0x420c0000, v87
  v_cos_f32 v96, v92
  v_sin_f32 v100, v92
  v_cos_f32 v97, v93
  v_sin_f32 v101, v93
  v_cos_f32 v98, v94
  v_sin_f32 v102, v94
  v_cos_f32 v99, v95
  v_sin_f32 v103, v95
  v_cvt_pk_bf16_f32 v44, v96, v100
  v_cvt_pk_bf16_f32 v45, v97, v101
  v_cvt_pk_bf16_f32 v46, v98, v102
  v_cvt_pk_bf16_f32 v47, v99, v103
  v_fmamk_f32 v92, v84, 0x42000000, v88
  v_fmamk_f32 v93, v84, 0x42040000, v88
  v_fmamk_f32 v94, v84, 0x42080000, v88
  v_fmamk_f32 v95, v84, 0x420c0000, v88
  v_cos_f32 v96, v92
  v_sin_f32 v100, v92
  v_cos_f32 v97, v93
  v_sin_f32 v101, v93
  v_cos_f32 v98, v94
  v_sin_f32 v102, v94
  v_cos_f32 v99, v95
  v_sin_f32 v103, v95
  v_cvt_pk_bf16_f32 v48, v96, v100
  v_cvt_pk_bf16_f32 v49, v97, v101
  v_cvt_pk_bf16_f32 v50, v98, v102
  v_cvt_pk_bf16_f32 v51, v99, v103
  v_fmamk_f32 v92, v85, 0x42000000, v89
  v_fmamk_f32 v93, v85, 0x42040000, v89
  v_fmamk_f32 v94, v85, 0x42080000, v89
  v_fmamk_f32 v95, v85, 0x420c0000, v89
  v_cos_f32 v96, v92
  v_sin_f32 v100, v92
  v_cos_f32 v97, v93
  v_sin_f32 v101, v93
  v_cos_f32 v98, v94
  v_sin_f32 v102, v94
  v_cos_f32 v99, v95
  v_sin_f32 v103, v95
  v_cvt_pk_bf16_f32 v52, v96, v100
  v_cvt_pk_bf16_f32 v53, v97, v101
  v_cvt_pk_bf16_f32 v54, v98, v102
  v_cvt_pk_bf16_f32 v55, v99, v103
  v_fmamk_f32 v92, v82, 0x42400000, v86
  v_fmamk_f32 v93, v82, 0x42440000, v86
  v_fmamk_f32 v94, v82, 0x42480000, v86
  v_fmamk_f32 v95, v82, 0x424c0000, v86
  v_cos_f32 v96, v92
  v_sin_f32 v100, v92
  v_cos_f32 v97, v93
  v_sin_f32 v101, v93
  v_cos_f32 v98, v94
  v_sin_f32 v102, v94
  v_cos_f32 v99, v95
  v_sin_f32 v103, v95
  v_cvt_pk_bf16_f32 v56, v96, v100
  v_cvt_pk_bf16_f32 v57, v97, v101
  v_cvt_pk_bf16_f32 v58, v98, v102
  v_cvt_pk_bf16_f32 v59, v99, v103
  v_fmamk_f32 v92, v83, 0x42400000, v87
  v_fmamk_f32 v93, v83, 0x42440000, v87
  v_fmamk_f32 v94, v83, 0x42480000, v87
  v_fmamk_f32 v95, v83, 0x424c0000, v87
  v_cos_f32 v96, v92
  v_sin_f32 v100, v92
  v_cos_f32 v97, v93
  v_sin_f32 v101, v93
  v_cos_f32 v98, v94
  v_sin_f32 v102, v94
  v_cos_f32 v99, v95
  v_sin_f32 v103, v95
  v_cvt_pk_bf16_f32 v60, v96, v100
  v_cvt_pk_bf16_f32 v61, v97, v101
  v_cvt_pk_bf16_f32 v62, v98, v102
  v_cvt_pk_bf16_f32 v63, v99, v103
  v_fmamk_f32 v92, v84, 0x42400000, v88
  v_fmamk_f32 v93, v84, 0x42440000, v88
  v_fmamk_f32 v94, v84, 0x42480000, v88
  v_fmamk_f32 v95, v84, 0x424c0000, v88
  v_cos_f32 v96, v92
  v_sin_f32 v100, v92
  v_cos_f32 v97, v93
  v_sin_f32 v101, v93
  v_cos_f32 v98, v94
  v_sin_f32 v102, v94
  v_cos_f32 v99, v95
  v_sin_f32 v103, v95
  v_cvt_pk_bf16_f32 v64, v96, v100
  v_cvt_pk_bf16_f32 v65, v97, v101
  v_cvt_pk_bf16_f32 v66, v98, v102
  v_cvt_pk_bf16_f32 v67, v99, v103
  v_fmamk_f32 v92, v85, 0x42400000, v89
  v_fmamk_f32 v93, v85, 0x42440000, v89
  v_fmamk_f32 v94, v85, 0x42480000, v89
  v_fmamk_f32 v95, v85, 0x424c0000, v89
  v_cos_f32 v96, v92
  v_sin_f32 v100, v92
  v_cos_f32 v97, v93
  v_sin_f32 v101, v93
  v_cos_f32 v98, v94
  v_sin_f32 v102, v94
  v_cos_f32 v99, v95
  v_sin_f32 v103, v95
  v_cvt_pk_bf16_f32 v68, v96, v100
  v_cvt_pk_bf16_f32 v69, v97, v101
  v_cvt_pk_bf16_f32 v70, v98, v102
  v_cvt_pk_bf16_f32 v71, v99, v103
  s_cmp_eq_u32 s3, 0
  s_cselect_b32 s76, 0xffff, 0
  s_mov_b32 s77, 0
  v_mov_b32 v80, 0xbf003f00
  v_and_b32 v81, 1, v1
  v_lshlrev_b32 v81, 31, v81
  v_xor_b32 v80, v80, v81
  v_cndmask_b32 v8, v8, v80, s[76:77]
  v_cndmask_b32 v12, v12, v80, s[76:77]
  v_cndmask_b32 v16, v16, v80, s[76:77]
  v_cndmask_b32 v20, v20, v80, s[76:77]
  v_add_u32 v7, s71, v3
  s_barrier
  ds_write_b128 v7, v[8:11] offset:24576
  ds_write_b128 v7, v[12:15] offset:25600
  ds_write_b128 v7, v[16:19] offset:26624
  ds_write_b128 v7, v[20:23] offset:27648
  ds_write_b128 v7, v[24:27] offset:28672
  ds_write_b128 v7, v[28:31] offset:29696
  ds_write_b128 v7, v[32:35] offset:30720
  ds_write_b128 v7, v[36:39] offset:31744
  ds_write_b128 v7, v[40:43] offset:0
  ds_write_b128 v7, v[44:47] offset:1024
  ds_write_b128 v7, v[48:51] offset:2048
  ds_write_b128 v7, v[52:55] offset:3072
  ds_write_b128 v7, v[56:59] offset:4096
  ds_write_b128 v7, v[60:63] offset:5120
  ds_write_b128 v7, v[64:67] offset:6144
  ds_write_b128 v7, v[68:71] offset:7168
  s_waitcnt lgkmcnt(0)
  s_barrier
  s_branch L_end
L_M:
  s_waitcnt lgkmcnt(0)
  s_setprio 1
  s_xor_b32 s56, s3, 3
  s_or_b32 s58, s56, s2
  s_cmp_eq_u32 s58, 0
  s_cselect_b32 s56, 0, 1073741824
  v_lshlrev_b32 v5, 7, v0
  v_add_u32 v5, s56, v5
  v_mov_b32 v6, 0
  s_mov_b32 s57, 4210688
  s_mov_b32 exec_hi, 0
  buffer_store_dword v6, v5, s[40:43], s57 offen sc1
  s_mov_b32 exec_hi, -1
  s_lshr_b32 s49, s2, 5
  s_and_b32 s50, s2, 31
  s_lshl_b32 s67, s3, 4
  v_add_u32 v92, s67, v1
  v_cvt_f32_u32 v92, v92
  v_mul_f32 v93, 0x3c800000, v92
  v_lshlrev_b32 v94, 2, v2
  v_cvt_f32_u32 v94, v94
  v_mul_f32 v95, v94, v93
  v_fmamk_f32 v101, v93, 0x3f800000, v95
  v_fmamk_f32 v102, v93, 0x40000000, v95
  v_fmamk_f32 v103, v93, 0x40400000, v95
  v_cos_f32 v104, v95
  v_sin_f32_e64 v108, -v95
  v_cos_f32 v105, v101
  v_sin_f32_e64 v109, -v101
  v_cos_f32 v106, v102
  v_sin_f32_e64 v110, -v102
  v_cos_f32 v107, v103
  v_sin_f32_e64 v111, -v103
  v_cvt_pk_bf16_f32 v60, v104, v105
  v_cvt_pk_bf16_f32 v68, v108, v109
  v_cvt_pk_bf16_f32 v61, v106, v107
  v_cvt_pk_bf16_f32 v69, v110, v111
  v_fmamk_f32 v100, v93, 0x41800000, v95
  v_fmamk_f32 v101, v93, 0x41880000, v95
  v_fmamk_f32 v102, v93, 0x41900000, v95
  v_fmamk_f32 v103, v93, 0x41980000, v95
  v_cos_f32 v104, v100
  v_sin_f32_e64 v108, -v100
  v_cos_f32 v105, v101
  v_sin_f32_e64 v109, -v101
  v_cos_f32 v106, v102
  v_sin_f32_e64 v110, -v102
  v_cos_f32 v107, v103
  v_sin_f32_e64 v111, -v103
  v_cvt_pk_bf16_f32 v62, v104, v105
  v_cvt_pk_bf16_f32 v70, v108, v109
  v_cvt_pk_bf16_f32 v63, v106, v107
  v_cvt_pk_bf16_f32 v71, v110, v111
  v_fmamk_f32 v100, v93, 0x42000000, v95
  v_fmamk_f32 v101, v93, 0x42040000, v95
  v_fmamk_f32 v102, v93, 0x42080000, v95
  v_fmamk_f32 v103, v93, 0x420c0000, v95
  v_cos_f32 v104, v100
  v_sin_f32_e64 v108, -v100
  v_cos_f32 v105, v101
  v_sin_f32_e64 v109, -v101
  v_cos_f32 v106, v102
  v_sin_f32_e64 v110, -v102
  v_cos_f32 v107, v103
  v_sin_f32_e64 v111, -v103
  v_cvt_pk_bf16_f32 v64, v104, v105
  v_cvt_pk_bf16_f32 v72, v108, v109
  v_cvt_pk_bf16_f32 v65, v106, v107
  v_cvt_pk_bf16_f32 v73, v110, v111
  v_fmamk_f32 v100, v93, 0x42400000, v95
  v_fmamk_f32 v101, v93, 0x42440000, v95
  v_fmamk_f32 v102, v93, 0x42480000, v95
  v_fmamk_f32 v103, v93, 0x424c0000, v95
  v_cos_f32 v104, v100
  v_sin_f32_e64 v108, -v100
  v_cos_f32 v105, v101
  v_sin_f32_e64 v109, -v101
  v_cos_f32 v106, v102
  v_sin_f32_e64 v110, -v102
  v_cos_f32 v107, v103
  v_sin_f32_e64 v111, -v103
  v_cvt_pk_bf16_f32 v66, v104, v105
  v_cvt_pk_bf16_f32 v74, v108, v109
  v_cvt_pk_bf16_f32 v67, v106, v107
  v_cvt_pk_bf16_f32 v75, v110, v111
  v_and_b32 v96, 1, v2
  v_lshlrev_b32 v96, 2, v96
  v_cvt_f32_u32 v96, v96
  v_mul_f32 v97, 0x3b000000, v92
  v_mul_f32 v98, v96, v97
  v_fmamk_f32 v101, v97, 0x3f800000, v98
  v_fmamk_f32 v102, v97, 0x40000000, v98
  v_fmamk_f32 v103, v97, 0x40400000, v98
  v_cos_f32 v76, v98
  v_sin_f32_e64 v80, -v98
  v_cos_f32 v77, v101
  v_sin_f32_e64 v81, -v101
  v_cos_f32 v78, v102
  v_sin_f32_e64 v82, -v102
  v_cos_f32 v79, v103
  v_sin_f32_e64 v83, -v103
  v_lshrrev_b32 v97, 2, v1
  v_cvt_f32_u32 v97, v97
  v_mul_f32 v97, 0x3e000000, v97
  v_and_b32 v98, 1, v1
  v_cvt_f32_u32 v98, v98
  v_mul_f32 v98, 0x3e800000, v98
  v_fma_f32 v98, v96, v97, v98
  v_lshrrev_b32 v99, 1, v1
  v_and_b32 v99, 1, v99
  v_lshrrev_b32 v92, 1, v2
  v_cmp_eq_u32 s[68:69], v99, v92
  v_and_b32 v99, 13, v1
  v_cmp_eq_u32 vcc, 1, v99
  s_nop 2
  s_and_b64 s[70:71], vcc, s[68:69]
  v_fmamk_f32 v101, v97, 0x3f800000, v98
  v_fmamk_f32 v102, v97, 0x40000000, v98
  v_fmamk_f32 v103, v97, 0x40400000, v98
  v_cos_f32 v104, v98
  v_sin_f32 v108, v98
  v_cos_f32 v105, v101
  v_sin_f32 v109, v101
  v_cos_f32 v106, v102
  v_sin_f32 v110, v102
  v_cos_f32 v107, v103
  v_sin_f32 v111, v103
  v_cvt_pk_bf16_f32 v100, v104, v108
  v_cvt_pk_bf16_f32 v101, v105, v109
  v_cvt_pk_bf16_f32 v102, v106, v110
  v_cvt_pk_bf16_f32 v103, v107, v111
  v_mov_b32 v104, 0x3f80
  v_mov_b32 v105, 0xbf80
  v_cndmask_b32 v84, 0, v100, s[68:69]
  v_cndmask_b32 v88, 0, v104, s[70:71]
  v_cndmask_b32 v85, 0, v101, s[68:69]
  v_cndmask_b32 v89, 0, v105, s[70:71]
  v_cndmask_b32 v86, 0, v102, s[68:69]
  v_cndmask_b32 v90, 0, v104, s[70:71]
  v_cndmask_b32 v87, 0, v103, s[68:69]
  v_cndmask_b32 v91, 0, v105, s[70:71]
  v_and_b32 v92, 3, v0
  v_lshrrev_b32 v93, 1, v92
  v_mul_u32_u24 v108, 1152, v93
  v_and_b32 v92, 1, v92
  v_lshlrev_b32 v92, 3, v92
  v_lshrrev_b32 v93, 2, v1
  v_lshl_add_u32 v93, v2, 2, v93
  v_lshlrev_b32 v93, 4, v93
  v_add3_u32 v108, v108, v92, v93
  v_add_u32 v108, 126976, v108
  s_mul_i32 s72, s3, 2304
  s_add_u32 s72, s72, 126976
  v_add_u32 v109, s72, v3
  v_add_u32 v110, 158720, v3
  s_lshl_b32 s84, s49, 3
  s_lshl_b32 s85, s3, 1
  s_add_u32 s84, s84, s85
  s_lshr_b32 s85, s84, 4
  s_lshl_b32 s85, s85, 11
  s_lshr_b32 s86, s50, 4
  s_lshl_b32 s86, s86, 10
  s_add_u32 s85, s85, s86
  s_lshr_b32 s86, s84, 2
  s_and_b32 s86, s86, 3
  s_lshl_b32 s86, s86, 8
  s_add_u32 s85, s85, s86
  s_and_b32 s86, s50, 15
  s_lshl_b32 s86, s86, 4
  s_add_u32 s85, s85, s86
  s_and_b32 s86, s84, 3
  s_lshl_b32 s86, s86, 2
  s_add_u32 s85, s85, s86
  s_add_u32 s85, s85, 4202496
  v_lshlrev_b32 v5, 7, v0
  v_mov_b32 v6, 1073741824
  v_cmp_gt_u32 vcc, 33, v0
  s_nop 1
  v_cndmask_b32 v7, v6, v5, vcc
  v_cmp_gt_u32 vcc, 56, v0
  s_nop 1
  v_cndmask_b32 v6, v6, v5, vcc
  s_cmp_eq_u32 s3, 2
  s_cselect_b32 s56, 0, 1073741824
  v_add_u32 v5, s56, v7
  s_cmp_eq_u32 s3, 3
  s_cselect_b32 s56, 0, 1073741824
  v_add_u32 v7, s56, v7
  s_cmp_eq_u32 s3, 0
  s_cselect_b32 s56, 0, 1073741824
  v_add_u32 v6, s56, v6
  s_mul_i32 s56, s2, 4224
  v_add_u32 v5, s56, v5
  v_add_u32 v7, s56, v7
  s_mul_i32 s57, s2, 7168
  buffer_load_dword v245, v5, s[12:15], 0 offen
  buffer_load_dword v245, v7, s[16:19], 0 offen
  buffer_load_dword v245, v6, s[28:31], s57 offen
  s_cmp_lg_u32 s58, 0
  s_cbranch_scc1 L_m_nos0
  s_waitcnt vmcnt(0)
  v_mov_b32 v5, 1
  v_mov_b32 v6, 32
  s_mov_b64 exec, 1
  buffer_store_dword v5, v6, s[44:47], 0 offen sc1
  s_mov_b64 exec, -1
L_m_nos0:
  s_barrier
  ds_read_b64_tr_b16 v[112:113], v108 offset:0
  ds_read_b64_tr_b16 v[114:115], v108 offset:256
  ds_read_b64_tr_b16 v[116:117], v108 offset:512
  ds_read_b64_tr_b16 v[118:119], v108 offset:768
  ds_read_b64_tr_b16 v[120:121], v108 offset:2304
  ds_read_b64_tr_b16 v[122:123], v108 offset:2560
  ds_read_b64_tr_b16 v[124:125], v108 offset:2816
  ds_read_b64_tr_b16 v[126:127], v108 offset:3072
  ds_read_b64_tr_b16 v[128:129], v108 offset:4608
  ds_read_b64_tr_b16 v[130:131], v108 offset:4864
  ds_read_b64_tr_b16 v[132:133], v108 offset:5120
  ds_read_b64_tr_b16 v[134:135], v108 offset:5376
  ds_read_b64_tr_b16 v[136:137], v108 offset:6912
  ds_read_b64_tr_b16 v[138:139], v108 offset:7168
  ds_read_b64_tr_b16 v[140:141], v108 offset:7424
  ds_read_b64_tr_b16 v[142:143], v108 offset:7680
  ds_read_b128 v[144:147], v109
  ds_read_b128 v[148:151], v109 offset:1152
  ds_read_b128 v[184:187], v110
  s_waitcnt lgkmcnt(11)
  v_mfma_f32_16x16x32_bf16 v[152:155], v[112:115], v[60:63], 0
  v_mfma_f32_16x16x32_bf16 v[168:171], v[112:115], v[68:71], 0
  v_mfma_f32_16x16x32_bf16 v[152:155], v[116:119], v[64:67], v[152:155]
  v_mfma_f32_16x16x32_bf16 v[168:171], v[116:119], v[72:75], v[168:171]
  v_mfma_f32_16x16x32_bf16 v[156:159], v[120:123], v[60:63], 0
  v_mfma_f32_16x16x32_bf16 v[172:175], v[120:123], v[68:71], 0
  v_mfma_f32_16x16x32_bf16 v[156:159], v[124:127], v[64:67], v[156:159]
  v_mfma_f32_16x16x32_bf16 v[172:175], v[124:127], v[72:75], v[172:175]
  s_waitcnt lgkmcnt(3)
  v_mfma_f32_16x16x32_bf16 v[160:163], v[128:131], v[60:63], 0
  v_mfma_f32_16x16x32_bf16 v[176:179], v[128:131], v[68:71], 0
  v_mfma_f32_16x16x32_bf16 v[160:163], v[132:135], v[64:67], v[160:163]
  v_mfma_f32_16x16x32_bf16 v[176:179], v[132:135], v[72:75], v[176:179]
  v_mfma_f32_16x16x32_bf16 v[164:167], v[136:139], v[60:63], 0
  v_mfma_f32_16x16x32_bf16 v[180:183], v[136:139], v[68:71], 0
  v_mfma_f32_16x16x32_bf16 v[164:167], v[140:143], v[64:67], v[164:167]
  v_mfma_f32_16x16x32_bf16 v[180:183], v[140:143], v[72:75], v[180:183]
  s_waitcnt lgkmcnt(0)
  v_dot2_f32_bf16 v94, v144, v184, 0
  v_dot2_f32_bf16 v95, v148, v184, 0
  v_dot2_f32_bf16 v94, v145, v185, v94
  v_dot2_f32_bf16 v95, v149, v185, v95
  v_dot2_f32_bf16 v94, v146, v186, v94
  v_dot2_f32_bf16 v95, v150, v186, v95
  v_dot2_f32_bf16 v94, v147, v187, v94
  v_dot2_f32_bf16 v95, v151, v187, v95
  v_pk_mul_f32 v[100:101], v[168:169], v[80:81]
  v_pk_mul_f32 v[104:105], v[170:171], v[82:83]
  v_pk_mul_f32 v[102:103], v[168:169], v[76:77]
  v_pk_mul_f32 v[106:107], v[170:171], v[78:79]
  v_pk_fma_f32 v[100:101], v[152:153], v[76:77], v[100:101] neg_lo:[0,0,1] neg_hi:[0,0,1]
  v_pk_fma_f32 v[104:105], v[154:155], v[78:79], v[104:105] neg_lo:[0,0,1] neg_hi:[0,0,1]
  v_pk_fma_f32 v[102:103], v[152:153], v[80:81], v[102:103]
  v_pk_fma_f32 v[106:107], v[154:155], v[82:83], v[106:107]
  v_cvt_pk_bf16_f32 v112, v100, v102
  v_cvt_pk_bf16_f32 v113, v101, v103
  v_cvt_pk_bf16_f32 v114, v104, v106
  v_cvt_pk_bf16_f32 v115, v105, v107
  v_add_f32_dpp v94, v94, v94 row_shr:1 row_mask:0xf bank_mask:0xf bound_ctrl:1
  v_add_f32_dpp v95, v95, v95 row_shr:1 row_mask:0xf bank_mask:0xf bound_ctrl:1
  s_nop 0
  v_add_f32_dpp v94, v94, v94 row_shr:2 row_mask:0xf bank_mask:0xf bound_ctrl:1
  v_add_f32_dpp v95, v95, v95 row_shr:2 row_mask:0xf bank_mask:0xf bound_ctrl:1
  v_pk_mul_f32 v[100:101], v[172:173], v[80:81]
  v_pk_mul_f32 v[104:105], v[174:175], v[82:83]
  v_pk_mul_f32 v[102:103], v[172:173], v[76:77]
  v_pk_mul_f32 v[106:107], v[174:175], v[78:79]
  v_pk_fma_f32 v[100:101], v[156:157], v[76:77], v[100:101] neg_lo:[0,0,1] neg_hi:[0,0,1]
  v_pk_fma_f32 v[104:105], v[158:159], v[78:79], v[104:105] neg_lo:[0,0,1] neg_hi:[0,0,1]
  v_pk_fma_f32 v[102:103], v[156:157], v[80:81], v[102:103]
  v_pk_fma_f32 v[106:107], v[158:159], v[82:83], v[106:107]
  v_cvt_pk_bf16_f32 v116, v100, v102
  v_cvt_pk_bf16_f32 v117, v101, v103
  v_cvt_pk_bf16_f32 v118, v104, v106
  v_cvt_pk_bf16_f32 v119, v105, v107
  v_add_f32_dpp v94, v94, v94 row_shr:4 row_mask:0xf bank_mask:0xf bound_ctrl:1
  v_add_f32_dpp v95, v95, v95 row_shr:4 row_mask:0xf bank_mask:0xf bound_ctrl:1
  s_nop 0
  v_add_f32_dpp v94, v94, v94 row_shr:8 row_mask:0xf bank_mask:0xf bound_ctrl:1
  v_add_f32_dpp v95, v95, v95 row_shr:8 row_mask:0xf bank_mask:0xf bound_ctrl:1
  v_pk_mul_f32 v[100:101], v[176:177], v[80:81]
  v_pk_mul_f32 v[104:105], v[178:179], v[82:83]
  v_pk_mul_f32 v[102:103], v[176:177], v[76:77]
  v_pk_mul_f32 v[106:107], v[178:179], v[78:79]
  v_pk_fma_f32 v[100:101], v[160:161], v[76:77], v[100:101] neg_lo:[0,0,1] neg_hi:[0,0,1]
  v_pk_fma_f32 v[104:105], v[162:163], v[78:79], v[104:105] neg_lo:[0,0,1] neg_hi:[0,0,1]
  v_pk_fma_f32 v[102:103], v[160:161], v[80:81], v[102:103]
  v_pk_fma_f32 v[106:107], v[162:163], v[82:83], v[106:107]
  v_cvt_pk_bf16_f32 v120, v100, v102
  v_cvt_pk_bf16_f32 v121, v101, v103
  v_cvt_pk_bf16_f32 v122, v104, v106
  v_cvt_pk_bf16_f32 v123, v105, v107
  v_add_f32_dpp v94, v94, v94 row_bcast:15 row_mask:0xa bank_mask:0xf
  v_add_f32_dpp v95, v95, v95 row_bcast:15 row_mask:0xa bank_mask:0xf
  v_pk_mul_f32 v[100:101], v[180:181], v[80:81]
  v_pk_mul_f32 v[104:105], v[182:183], v[82:83]
  v_pk_mul_f32 v[102:103], v[180:181], v[76:77]
  v_pk_mul_f32 v[106:107], v[182:183], v[78:79]
  v_pk_fma_f32 v[100:101], v[164:165], v[76:77], v[100:101] neg_lo:[0,0,1] neg_hi:[0,0,1]
  v_pk_fma_f32 v[104:105], v[166:167], v[78:79], v[104:105] neg_lo:[0,0,1] neg_hi:[0,0,1]
  v_pk_fma_f32 v[102:103], v[164:165], v[80:81], v[102:103]
  v_pk_fma_f32 v[106:107], v[166:167], v[82:83], v[106:107]
  v_cvt_pk_bf16_f32 v124, v100, v102
  v_cvt_pk_bf16_f32 v125, v101, v103
  v_cvt_pk_bf16_f32 v126, v104, v106
  v_cvt_pk_bf16_f32 v127, v105, v107
  v_add_f32_dpp v94, v94, v94 row_bcast:31 row_mask:0xc bank_mask:0xf
  v_add_f32_dpp v95, v95, v95 row_bcast:31 row_mask:0xc bank_mask:0xf
  v_mfma_f32_16x16x32_bf16 v[152:155], v[84:87], v[112:115], 0
  v_mfma_f32_16x16x32_bf16 v[168:171], v[88:91], v[112:115], 0
  v_mfma_f32_16x16x32_bf16 v[156:159], v[84:87], v[116:119], 0
  v_mfma_f32_16x16x32_bf16 v[172:175], v[88:91], v[116:119], 0
  v_mfma_f32_16x16x32_bf16 v[160:163], v[84:87], v[120:123], 0
  v_mfma_f32_16x16x32_bf16 v[176:179], v[88:91], v[120:123], 0
  v_mfma_f32_16x16x32_bf16 v[164:167], v[84:87], v[124:127], 0
  v_mfma_f32_16x16x32_bf16 v[180:183], v[88:91], v[124:127], 0
  v_mul_f32 v94, 0xbfb8aa3b, v94
  v_mul_f32 v95, 0xbfb8aa3b, v95
  v_exp_f32 v94, v94
  v_exp_f32 v95, v95
  v_add_f32 v94, 1.0, v94
  v_add_f32 v95, 1.0, v95
  v_rcp_f32 v96, v94
  v_rcp_f32 v97, v95
  s_cmp_eq_u32 s3, 0
  s_cselect_b32 s74, 1, 0
  s_mov_b32 s75, 0
  v_cndmask_b32 v153, v153, v169, s[74:75]
  v_cvt_pk_bf16_f32 v8, v152, v153
  v_cndmask_b32 v155, v155, v171, s[74:75]
  v_cvt_pk_bf16_f32 v9, v154, v155
  v_cndmask_b32 v157, v157, v173, s[74:75]
  v_cvt_pk_bf16_f32 v10, v156, v157
  v_cndmask_b32 v159, v159, v175, s[74:75]
  v_cvt_pk_bf16_f32 v11, v158, v159
  v_cndmask_b32 v161, v161, v177, s[74:75]
  v_cvt_pk_bf16_f32 v12, v160, v161
  v_cndmask_b32 v163, v163, v179, s[74:75]
  v_cvt_pk_bf16_f32 v13, v162, v163
  v_cndmask_b32 v165, v165, v181, s[74:75]
  v_cvt_pk_bf16_f32 v14, v164, v165
  v_cndmask_b32 v167, v167, v183, s[74:75]
  v_cvt_pk_bf16_f32 v15, v166, v167
  v_lshrrev_b32 v18, 5, v0
  v_lshlrev_b32 v18, 11, v18
  v_and_b32 v19, 31, v0
  v_lshl_add_u32 v18, v19, 4, v18
  s_lshl_b32 s93, s3, 9
  v_add_u32 v18, s93, v18
  s_lshl_b32 s90, s2, 13
  s_add_u32 s90, s90, 0
  v_mov_b32 v16, v96
  v_mov_b32 v17, v97
  v_mov_b32 v19, 0
  s_mov_b32 s91, s85
  s_lshl_b32 s76, s3, 12
  v_lshlrev_b32 v234, 7, v1
  v_add_u32 v234, s76, v234
  v_lshrrev_b32 v235, 1, v1
  v_xor_b32 v235, v235, v2
  v_lshl_add_u32 v96, v235, 4, v234
  v_xor_b32 v235, 4, v235
  v_lshl_add_u32 v97, v235, 4, v234
  v_mul_u32_u24 v102, 1920, v2
  v_lshrrev_b32 v234, 2, v1
  v_mul_u32_u24 v234, 224, v234
  v_and_b32 v235, 3, v0
  v_lshlrev_b32 v235, 3, v235
  v_add3_u32 v102, v102, v234, v235
  v_add_u32 v102, 16384, v102
  s_cmp_eq_u32 s48, 0
  s_cselect_b32 s76, 192, 0
  v_add_u32 v103, s76, v102
  s_lshl_b32 s76, s48, 5
  v_add_u32 v102, s76, v102
  v_add_u32 v98, 63488, v96
  v_add_u32 v104, 63488, v102
  v_add_u32 v99, 63488, v97
  v_add_u32 v105, 63488, v103
  v_add_u32 v100, 126976, v96
  v_add_u32 v106, 126976, v102
  v_add_u32 v101, 126976, v97
  v_add_u32 v107, 126976, v103
  v_lshlrev_b32 v234, 3, v2
  s_lshl_b32 s76, s48, 5
  s_add_u32 s77, s76, 159744
  v_add_u32 v235, s77, v234
  s_cmp_eq_u32 s48, 0
  s_cselect_b32 s77, 192, 0
  s_add_u32 s77, s77, 159744
  v_add_u32 v234, s77, v234
  s_barrier
  s_mul_i32 s93, s3, 2304
  s_add_u32 s93, s93, 126976
  v_lshl_add_u32 v20, v0, 5, s93
  v_add_u32 v21, s93, v3
  ds_write_b128 v20, v[8:11]
  ds_write_b128 v20, v[12:15] offset:16
  s_waitcnt lgkmcnt(0)
  ds_read_b128 v[8:11], v21
  ds_read_b128 v[12:15], v21 offset:1024
  ds_read_b64 v[220:221], v235 offset:0
  ds_read_b64 v[222:223], v235 offset:32
  ds_read_b64 v[224:225], v235 offset:64
  ds_read_b64 v[226:227], v235 offset:96
  ds_read_b64 v[228:229], v235 offset:128
  ds_read_b64 v[230:231], v235 offset:160
  ds_read_b64 v[232:233], v234
  ds_read_b128 v[80:83], v96 offset:0
  ds_read_b128 v[84:87], v96 offset:2048
  ds_read_b64_tr_b16 v[192:193], v102 offset:0
  ds_read_b64_tr_b16 v[194:195], v102 offset:960
  ds_read_b64_tr_b16 v[196:197], v102 offset:32
  ds_read_b64_tr_b16 v[198:199], v102 offset:992
  ds_read_b64_tr_b16 v[200:201], v102 offset:64
  ds_read_b64_tr_b16 v[202:203], v102 offset:1024
  s_waitcnt lgkmcnt(8)
  v_lshlrev_b32 v108, 16, v220
  v_and_b32 v109, 0xffff0000, v220
  v_lshlrev_b32 v110, 16, v221
  v_and_b32 v111, 0xffff0000, v221
  v_lshlrev_b32 v112, 16, v222
  v_and_b32 v113, 0xffff0000, v222
  v_lshlrev_b32 v114, 16, v223
  v_and_b32 v115, 0xffff0000, v223
  v_lshlrev_b32 v116, 16, v224
  v_and_b32 v117, 0xffff0000, v224
  v_lshlrev_b32 v118, 16, v225
  v_and_b32 v119, 0xffff0000, v225
  v_lshlrev_b32 v120, 16, v226
  v_and_b32 v121, 0xffff0000, v226
  v_lshlrev_b32 v122, 16, v227
  v_and_b32 v123, 0xffff0000, v227
  v_lshlrev_b32 v124, 16, v228
  v_and_b32 v125, 0xffff0000, v228
  v_lshlrev_b32 v126, 16, v229
  v_and_b32 v127, 0xffff0000, v229
  v_lshlrev_b32 v128, 16, v230
  v_and_b32 v129, 0xffff0000, v230
  v_lshlrev_b32 v130, 16, v231
  v_and_b32 v131, 0xffff0000, v231
  v_lshlrev_b32 v132, 16, v232
  v_and_b32 v133, 0xffff0000, v232
  v_lshlrev_b32 v134, 16, v233
  v_and_b32 v135, 0xffff0000, v233
  ds_read_b64_tr_b16 v[204:205], v102 offset:96
  ds_read_b64_tr_b16 v[206:207], v102 offset:1056
  ds_read_b64_tr_b16 v[208:209], v102 offset:128
  ds_read_b64_tr_b16 v[210:211], v102 offset:1088
  ds_read_b64_tr_b16 v[212:213], v102 offset:160
  ds_read_b64_tr_b16 v[214:215], v102 offset:1120
  ds_read_b64_tr_b16 v[216:217], v103 offset:0
  ds_read_b64_tr_b16 v[218:219], v103 offset:960
  s_waitcnt lgkmcnt(12)
  v_mfma_f32_16x16x32_bf16 v[136:139], v[192:195], v[80:83], v[108:111]
  v_mfma_f32_16x16x32_bf16 v[164:167], v[192:195], v[84:87], v[108:111]
  s_waitcnt lgkmcnt(10)
  v_mfma_f32_16x16x32_bf16 v[140:143], v[196:199], v[80:83], v[112:115]
  ds_read_b64_tr_b16 v[192:193], v102 offset:7680
  v_mfma_f32_16x16x32_bf16 v[168:171], v[196:199], v[84:87], v[112:115]
  ds_read_b64_tr_b16 v[194:195], v102 offset:8640
  s_waitcnt lgkmcnt(10)
  v_mfma_f32_16x16x32_bf16 v[144:147], v[200:203], v[80:83], v[116:119]
  ds_read_b64_tr_b16 v[196:197], v102 offset:7712
  ds_read_b128 v[88:91], v97 offset:0
  v_mfma_f32_16x16x32_bf16 v[172:175], v[200:203], v[84:87], v[116:119]
  ds_read_b64_tr_b16 v[198:199], v102 offset:8672
  ds_read_b128 v[92:95], v97 offset:2048
  s_waitcnt lgkmcnt(12)
  v_mfma_f32_16x16x32_bf16 v[148:151], v[204:207], v[80:83], v[120:123]
  ds_read_b64_tr_b16 v[200:201], v102 offset:7744
  v_mfma_f32_16x16x32_bf16 v[176:179], v[204:207], v[84:87], v[120:123]
  ds_read_b64_tr_b16 v[202:203], v102 offset:8704
  s_waitcnt lgkmcnt(12)
  v_mfma_f32_16x16x32_bf16 v[152:155], v[208:211], v[80:83], v[124:127]
  ds_read_b64_tr_b16 v[204:205], v102 offset:7776
  v_mfma_f32_16x16x32_bf16 v[180:183], v[208:211], v[84:87], v[124:127]
  ds_read_b64_tr_b16 v[206:207], v102 offset:8736
  s_waitcnt lgkmcnt(12)
  v_mfma_f32_16x16x32_bf16 v[156:159], v[212:215], v[80:83], v[128:131]
  ds_read_b64_tr_b16 v[208:209], v102 offset:7808
  v_mfma_f32_16x16x32_bf16 v[184:187], v[212:215], v[84:87], v[128:131]
  ds_read_b64_tr_b16 v[210:211], v102 offset:8768
  s_waitcnt lgkmcnt(12)
  v_mfma_f32_16x16x32_bf16 v[160:163], v[216:219], v[80:83], v[132:135]
  ds_read_b64_tr_b16 v[212:213], v102 offset:7840
  v_mfma_f32_16x16x32_bf16 v[188:191], v[216:219], v[84:87], v[132:135]
  ds_read_b64_tr_b16 v[214:215], v102 offset:8800
  s_waitcnt lgkmcnt(8)
  v_mfma_f32_16x16x32_bf16 v[136:139], v[192:195], v[88:91], v[136:139]
  ds_read_b64_tr_b16 v[216:217], v103 offset:7680
  v_mfma_f32_16x16x32_bf16 v[164:167], v[192:195], v[92:95], v[164:167]
  ds_read_b64_tr_b16 v[218:219], v103 offset:8640
  s_waitcnt lgkmcnt(10)
  v_mfma_f32_16x16x32_bf16 v[140:143], v[196:199], v[88:91], v[140:143]
  s_barrier
  ds_read_b64_tr_b16 v[192:193], v102 offset:31744
  v_mfma_f32_16x16x32_bf16 v[168:171], v[196:199], v[92:95], v[168:171]
  ds_read_b64_tr_b16 v[194:195], v102 offset:32704
  s_waitcnt lgkmcnt(10)
  v_mfma_f32_16x16x32_bf16 v[144:147], v[200:203], v[88:91], v[144:147]
  ds_read_b64_tr_b16 v[196:197], v102 offset:31776
  ds_read_b128 v[80:83], v96 offset:31744
  v_mfma_f32_16x16x32_bf16 v[172:175], v[200:203], v[92:95], v[172:175]
  ds_read_b64_tr_b16 v[198:199], v102 offset:32736
  ds_read_b128 v[84:87], v96 offset:33792
  s_waitcnt lgkmcnt(12)
  v_mfma_f32_16x16x32_bf16 v[148:151], v[204:207], v[88:91], v[148:151]
  ds_read_b64_tr_b16 v[200:201], v102 offset:31808
  v_mfma_f32_16x16x32_bf16 v[176:179], v[204:207], v[92:95], v[176:179]
  ds_read_b64_tr_b16 v[202:203], v102 offset:32768
  s_waitcnt lgkmcnt(12)
  v_mfma_f32_16x16x32_bf16 v[152:155], v[208:211], v[88:91], v[152:155]
  ds_read_b64_tr_b16 v[204:205], v102 offset:31840
  v_mfma_f32_16x16x32_bf16 v[180:183], v[208:211], v[92:95], v[180:183]
  ds_read_b64_tr_b16 v[206:207], v102 offset:32800
  s_waitcnt lgkmcnt(12)
  v_mfma_f32_16x16x32_bf16 v[156:159], v[212:215], v[88:91], v[156:159]
  ds_read_b64_tr_b16 v[208:209], v102 offset:31872
  v_mfma_f32_16x16x32_bf16 v[184:187], v[212:215], v[92:95], v[184:187]
  ds_read_b64_tr_b16 v[210:211], v102 offset:32832
  s_waitcnt lgkmcnt(12)
  v_mfma_f32_16x16x32_bf16 v[160:163], v[216:219], v[88:91], v[160:163]
  ds_read_b64_tr_b16 v[212:213], v102 offset:31904
  v_mfma_f32_16x16x32_bf16 v[188:191], v[216:219], v[92:95], v[188:191]
  ds_read_b64_tr_b16 v[214:215], v102 offset:32864
  s_waitcnt lgkmcnt(8)
  v_mfma_f32_16x16x32_bf16 v[136:139], v[192:195], v[80:83], v[136:139]
  ds_read_b64_tr_b16 v[216:217], v103 offset:31744
  v_mfma_f32_16x16x32_bf16 v[164:167], v[192:195], v[84:87], v[164:167]
  ds_read_b64_tr_b16 v[218:219], v103 offset:32704
  s_waitcnt lgkmcnt(10)
  v_mfma_f32_16x16x32_bf16 v[140:143], v[196:199], v[80:83], v[140:143]
  ds_read_b64_tr_b16 v[192:193], v102 offset:39424
  v_mfma_f32_16x16x32_bf16 v[168:171], v[196:199], v[84:87], v[168:171]
  ds_read_b64_tr_b16 v[194:195], v102 offset:40384
  s_waitcnt lgkmcnt(10)
  v_mfma_f32_16x16x32_bf16 v[144:147], v[200:203], v[80:83], v[144:147]
  ds_read_b64_tr_b16 v[196:197], v102 offset:39456
  ds_read_b128 v[88:91], v97 offset:31744
  v_mfma_f32_16x16x32_bf16 v[172:175], v[200:203], v[84:87], v[172:175]
  ds_read_b64_tr_b16 v[198:199], v102 offset:40416
  ds_read_b128 v[92:95], v97 offset:33792
  s_waitcnt lgkmcnt(12)
  v_mfma_f32_16x16x32_bf16 v[148:151], v[204:207], v[80:83], v[148:151]
  ds_read_b64_tr_b16 v[200:201], v102 offset:39488
  v_mfma_f32_16x16x32_bf16 v[176:179], v[204:207], v[84:87], v[176:179]
  ds_read_b64_tr_b16 v[202:203], v102 offset:40448
  s_waitcnt lgkmcnt(12)
  v_mfma_f32_16x16x32_bf16 v[152:155], v[208:211], v[80:83], v[152:155]
  ds_read_b64_tr_b16 v[204:205], v102 offset:39520
  v_mfma_f32_16x16x32_bf16 v[180:183], v[208:211], v[84:87], v[180:183]
  ds_read_b64_tr_b16 v[206:207], v102 offset:40480
  s_waitcnt lgkmcnt(12)
  v_mfma_f32_16x16x32_bf16 v[156:159], v[212:215], v[80:83], v[156:159]
  ds_read_b64_tr_b16 v[208:209], v102 offset:39552
  v_mfma_f32_16x16x32_bf16 v[184:187], v[212:215], v[84:87], v[184:187]
  ds_read_b64_tr_b16 v[210:211], v102 offset:40512
  s_waitcnt lgkmcnt(12)
  v_mfma_f32_16x16x32_bf16 v[160:163], v[216:219], v[80:83], v[160:163]
  ds_read_b64_tr_b16 v[212:213], v102 offset:39584
  v_mfma_f32_16x16x32_bf16 v[188:191], v[216:219], v[84:87], v[188:191]
  ds_read_b64_tr_b16 v[214:215], v102 offset:40544
  s_waitcnt lgkmcnt(8)
  v_mfma_f32_16x16x32_bf16 v[136:139], v[192:195], v[88:91], v[136:139]
  ds_read_b64_tr_b16 v[216:217], v103 offset:39424
  v_mfma_f32_16x16x32_bf16 v[164:167], v[192:195], v[92:95], v[164:167]
  ds_read_b64_tr_b16 v[218:219], v103 offset:40384
  s_waitcnt lgkmcnt(10)
  v_mfma_f32_16x16x32_bf16 v[140:143], v[196:199], v[88:91], v[140:143]
  s_barrier
  ds_read_b64_tr_b16 v[192:193], v104 offset:0
  v_mfma_f32_16x16x32_bf16 v[168:171], v[196:199], v[92:95], v[168:171]
  ds_read_b64_tr_b16 v[194:195], v104 offset:960
  s_waitcnt lgkmcnt(10)
  v_mfma_f32_16x16x32_bf16 v[144:147], v[200:203], v[88:91], v[144:147]
  ds_read_b64_tr_b16 v[196:197], v104 offset:32
  ds_read_b128 v[80:83], v98 offset:0
  v_mfma_f32_16x16x32_bf16 v[172:175], v[200:203], v[92:95], v[172:175]
  ds_read_b64_tr_b16 v[198:199], v104 offset:992
  ds_read_b128 v[84:87], v98 offset:2048
  s_waitcnt lgkmcnt(12)
  v_mfma_f32_16x16x32_bf16 v[148:151], v[204:207], v[88:91], v[148:151]
  ds_read_b64_tr_b16 v[200:201], v104 offset:64
  v_mfma_f32_16x16x32_bf16 v[176:179], v[204:207], v[92:95], v[176:179]
  ds_read_b64_tr_b16 v[202:203], v104 offset:1024
  s_waitcnt lgkmcnt(12)
  v_mfma_f32_16x16x32_bf16 v[152:155], v[208:211], v[88:91], v[152:155]
  ds_read_b64_tr_b16 v[204:205], v104 offset:96
  v_mfma_f32_16x16x32_bf16 v[180:183], v[208:211], v[92:95], v[180:183]
  ds_read_b64_tr_b16 v[206:207], v104 offset:1056
  s_waitcnt lgkmcnt(12)
  v_mfma_f32_16x16x32_bf16 v[156:159], v[212:215], v[88:91], v[156:159]
  ds_read_b64_tr_b16 v[208:209], v104 offset:128
  v_mfma_f32_16x16x32_bf16 v[184:187], v[212:215], v[92:95], v[184:187]
  ds_read_b64_tr_b16 v[210:211], v104 offset:1088
  s_waitcnt lgkmcnt(12)
  v_mfma_f32_16x16x32_bf16 v[160:163], v[216:219], v[88:91], v[160:163]
  ds_read_b64_tr_b16 v[212:213], v104 offset:160
  v_mfma_f32_16x16x32_bf16 v[188:191], v[216:219], v[92:95], v[188:191]
  ds_read_b64_tr_b16 v[214:215], v104 offset:1120
  s_waitcnt lgkmcnt(8)
  v_mfma_f32_16x16x32_bf16 v[136:139], v[192:195], v[80:83], v[136:139]
  ds_read_b64_tr_b16 v[216:217], v105 offset:0
  v_mfma_f32_16x16x32_bf16 v[164:167], v[192:195], v[84:87], v[164:167]
  ds_read_b64_tr_b16 v[218:219], v105 offset:960
  s_waitcnt lgkmcnt(10)
  v_mfma_f32_16x16x32_bf16 v[140:143], v[196:199], v[80:83], v[140:143]
  ds_read_b64_tr_b16 v[192:193], v104 offset:7680
  v_mfma_f32_16x16x32_bf16 v[168:171], v[196:199], v[84:87], v[168:171]
  ds_read_b64_tr_b16 v[194:195], v104 offset:8640
  s_waitcnt lgkmcnt(10)
  v_mfma_f32_16x16x32_bf16 v[144:147], v[200:203], v[80:83], v[144:147]
  ds_read_b64_tr_b16 v[196:197], v104 offset:7712
  ds_read_b128 v[88:91], v99 offset:0
  v_mfma_f32_16x16x32_bf16 v[172:175], v[200:203], v[84:87], v[172:175]
  ds_read_b64_tr_b16 v[198:199], v104 offset:8672
  ds_read_b128 v[92:95], v99 offset:2048
  s_waitcnt lgkmcnt(12)
  v_mfma_f32_16x16x32_bf16 v[148:151], v[204:207], v[80:83], v[148:151]
  ds_read_b64_tr_b16 v[200:201], v104 offset:7744
  v_mfma_f32_16x16x32_bf16 v[176:179], v[204:207], v[84:87], v[176:179]
  ds_read_b64_tr_b16 v[202:203], v104 offset:8704
  s_waitcnt lgkmcnt(12)
  v_mfma_f32_16x16x32_bf16 v[152:155], v[208:211], v[80:83], v[152:155]
  ds_read_b64_tr_b16 v[204:205], v104 offset:7776
  v_mfma_f32_16x16x32_bf16 v[180:183], v[208:211], v[84:87], v[180:183]
  ds_read_b64_tr_b16 v[206:207], v104 offset:8736
  s_waitcnt lgkmcnt(12)
  v_mfma_f32_16x16x32_bf16 v[156:159], v[212:215], v[80:83], v[156:159]
  ds_read_b64_tr_b16 v[208:209], v104 offset:7808
  v_mfma_f32_16x16x32_bf16 v[184:187], v[212:215], v[84:87], v[184:187]
  ds_read_b64_tr_b16 v[210:211], v104 offset:8768
  s_waitcnt lgkmcnt(12)
  v_mfma_f32_16x16x32_bf16 v[160:163], v[216:219], v[80:83], v[160:163]
  ds_read_b64_tr_b16 v[212:213], v104 offset:7840
  v_mfma_f32_16x16x32_bf16 v[188:191], v[216:219], v[84:87], v[188:191]
  ds_read_b64_tr_b16 v[214:215], v104 offset:8800
  s_waitcnt lgkmcnt(8)
  v_mfma_f32_16x16x32_bf16 v[136:139], v[192:195], v[88:91], v[136:139]
  ds_read_b64_tr_b16 v[216:217], v105 offset:7680
  v_mfma_f32_16x16x32_bf16 v[164:167], v[192:195], v[92:95], v[164:167]
  ds_read_b64_tr_b16 v[218:219], v105 offset:8640
  s_waitcnt lgkmcnt(10)
  v_mfma_f32_16x16x32_bf16 v[140:143], v[196:199], v[88:91], v[140:143]
  s_barrier
  ds_read_b64_tr_b16 v[192:193], v104 offset:31744
  v_mfma_f32_16x16x32_bf16 v[168:171], v[196:199], v[92:95], v[168:171]
  ds_read_b64_tr_b16 v[194:195], v104 offset:32704
  s_waitcnt lgkmcnt(10)
  v_mfma_f32_16x16x32_bf16 v[144:147], v[200:203], v[88:91], v[144:147]
  ds_read_b64_tr_b16 v[196:197], v104 offset:31776
  ds_read_b128 v[80:83], v98 offset:31744
  v_mfma_f32_16x16x32_bf16 v[172:175], v[200:203], v[92:95], v[172:175]
  ds_read_b64_tr_b16 v[198:199], v104 offset:32736
  ds_read_b128 v[84:87], v98 offset:33792
  s_waitcnt lgkmcnt(12)
  v_mfma_f32_16x16x32_bf16 v[148:151], v[204:207], v[88:91], v[148:151]
  ds_read_b64_tr_b16 v[200:201], v104 offset:31808
  v_mfma_f32_16x16x32_bf16 v[176:179], v[204:207], v[92:95], v[176:179]
  ds_read_b64_tr_b16 v[202:203], v104 offset:32768
  s_waitcnt lgkmcnt(12)
  v_mfma_f32_16x16x32_bf16 v[152:155], v[208:211], v[88:91], v[152:155]
  ds_read_b64_tr_b16 v[204:205], v104 offset:31840
  v_mfma_f32_16x16x32_bf16 v[180:183], v[208:211], v[92:95], v[180:183]
  ds_read_b64_tr_b16 v[206:207], v104 offset:32800
  s_waitcnt lgkmcnt(12)
  v_mfma_f32_16x16x32_bf16 v[156:159], v[212:215], v[88:91], v[156:159]
  ds_read_b64_tr_b16 v[208:209], v104 offset:31872
  v_mfma_f32_16x16x32_bf16 v[184:187], v[212:215], v[92:95], v[184:187]
  ds_read_b64_tr_b16 v[210:211], v104 offset:32832
  s_waitcnt lgkmcnt(12)
  v_mfma_f32_16x16x32_bf16 v[160:163], v[216:219], v[88:91], v[160:163]
  ds_read_b64_tr_b16 v[212:213], v104 offset:31904
  v_mfma_f32_16x16x32_bf16 v[188:191], v[216:219], v[92:95], v[188:191]
  ds_read_b64_tr_b16 v[214:215], v104 offset:32864
  s_waitcnt lgkmcnt(8)
  v_mfma_f32_16x16x32_bf16 v[136:139], v[192:195], v[80:83], v[136:139]
  ds_read_b64_tr_b16 v[216:217], v105 offset:31744
  v_mfma_f32_16x16x32_bf16 v[164:167], v[192:195], v[84:87], v[164:167]
  ds_read_b64_tr_b16 v[218:219], v105 offset:32704
  s_waitcnt lgkmcnt(10)
  v_mfma_f32_16x16x32_bf16 v[140:143], v[196:199], v[80:83], v[140:143]
  ds_read_b64_tr_b16 v[192:193], v104 offset:39424
  v_mfma_f32_16x16x32_bf16 v[168:171], v[196:199], v[84:87], v[168:171]
  ds_read_b64_tr_b16 v[194:195], v104 offset:40384
  s_waitcnt lgkmcnt(10)
  v_mfma_f32_16x16x32_bf16 v[144:147], v[200:203], v[80:83], v[144:147]
  ds_read_b64_tr_b16 v[196:197], v104 offset:39456
  ds_read_b128 v[88:91], v99 offset:31744
  v_mfma_f32_16x16x32_bf16 v[172:175], v[200:203], v[84:87], v[172:175]
  ds_read_b64_tr_b16 v[198:199], v104 offset:40416
  ds_read_b128 v[92:95], v99 offset:33792
  s_waitcnt lgkmcnt(12)
  v_mfma_f32_16x16x32_bf16 v[148:151], v[204:207], v[80:83], v[148:151]
  ds_read_b64_tr_b16 v[200:201], v104 offset:39488
  v_mfma_f32_16x16x32_bf16 v[176:179], v[204:207], v[84:87], v[176:179]
  ds_read_b64_tr_b16 v[202:203], v104 offset:40448
  s_waitcnt lgkmcnt(12)
  v_mfma_f32_16x16x32_bf16 v[152:155], v[208:211], v[80:83], v[152:155]
  ds_read_b64_tr_b16 v[204:205], v104 offset:39520
  v_mfma_f32_16x16x32_bf16 v[180:183], v[208:211], v[84:87], v[180:183]
  ds_read_b64_tr_b16 v[206:207], v104 offset:40480
  s_waitcnt lgkmcnt(12)
  v_mfma_f32_16x16x32_bf16 v[156:159], v[212:215], v[80:83], v[156:159]
  ds_read_b64_tr_b16 v[208:209], v104 offset:39552
  v_mfma_f32_16x16x32_bf16 v[184:187], v[212:215], v[84:87], v[184:187]
  ds_read_b64_tr_b16 v[210:211], v104 offset:40512
  s_waitcnt lgkmcnt(12)
  v_mfma_f32_16x16x32_bf16 v[160:163], v[216:219], v[80:83], v[160:163]
  ds_read_b64_tr_b16 v[212:213], v104 offset:39584
  v_mfma_f32_16x16x32_bf16 v[188:191], v[216:219], v[84:87], v[188:191]
  ds_read_b64_tr_b16 v[214:215], v104 offset:40544
  s_waitcnt lgkmcnt(8)
  v_mfma_f32_16x16x32_bf16 v[136:139], v[192:195], v[88:91], v[136:139]
  ds_read_b64_tr_b16 v[216:217], v105 offset:39424
  v_mfma_f32_16x16x32_bf16 v[164:167], v[192:195], v[92:95], v[164:167]
  ds_read_b64_tr_b16 v[218:219], v105 offset:40384
  s_waitcnt lgkmcnt(10)
  v_mfma_f32_16x16x32_bf16 v[140:143], v[196:199], v[88:91], v[140:143]
  s_barrier
  ds_read_b64_tr_b16 v[192:193], v106 offset:0
  v_mfma_f32_16x16x32_bf16 v[168:171], v[196:199], v[92:95], v[168:171]
  ds_read_b64_tr_b16 v[194:195], v106 offset:960
  s_waitcnt lgkmcnt(10)
  v_mfma_f32_16x16x32_bf16 v[144:147], v[200:203], v[88:91], v[144:147]
  ds_read_b64_tr_b16 v[196:197], v106 offset:32
  ds_read_b128 v[80:83], v100 offset:0
  v_mfma_f32_16x16x32_bf16 v[172:175], v[200:203], v[92:95], v[172:175]
  ds_read_b64_tr_b16 v[198:199], v106 offset:992
  ds_read_b128 v[84:87], v100 offset:2048
  s_waitcnt lgkmcnt(12)
  v_mfma_f32_16x16x32_bf16 v[148:151], v[204:207], v[88:91], v[148:151]
  ds_read_b64_tr_b16 v[200:201], v106 offset:64
  v_mfma_f32_16x16x32_bf16 v[176:179], v[204:207], v[92:95], v[176:179]
  ds_read_b64_tr_b16 v[202:203], v106 offset:1024
  s_waitcnt lgkmcnt(12)
  v_mfma_f32_16x16x32_bf16 v[152:155], v[208:211], v[88:91], v[152:155]
  ds_read_b64_tr_b16 v[204:205], v106 offset:96
  v_mfma_f32_16x16x32_bf16 v[180:183], v[208:211], v[92:95], v[180:183]
  ds_read_b64_tr_b16 v[206:207], v106 offset:1056
  s_waitcnt lgkmcnt(12)
  v_mfma_f32_16x16x32_bf16 v[156:159], v[212:215], v[88:91], v[156:159]
  ds_read_b64_tr_b16 v[208:209], v106 offset:128
  v_mfma_f32_16x16x32_bf16 v[184:187], v[212:215], v[92:95], v[184:187]
  ds_read_b64_tr_b16 v[210:211], v106 offset:1088
  s_waitcnt lgkmcnt(12)
  v_mfma_f32_16x16x32_bf16 v[160:163], v[216:219], v[88:91], v[160:163]
  ds_read_b64_tr_b16 v[212:213], v106 offset:160
  v_mfma_f32_16x16x32_bf16 v[188:191], v[216:219], v[92:95], v[188:191]
  ds_read_b64_tr_b16 v[214:215], v106 offset:1120
  s_waitcnt lgkmcnt(8)
  v_mfma_f32_16x16x32_bf16 v[136:139], v[192:195], v[80:83], v[136:139]
  ds_read_b64_tr_b16 v[216:217], v107 offset:0
  v_mfma_f32_16x16x32_bf16 v[164:167], v[192:195], v[84:87], v[164:167]
  ds_read_b64_tr_b16 v[218:219], v107 offset:960
  s_waitcnt lgkmcnt(10)
  v_mfma_f32_16x16x32_bf16 v[140:143], v[196:199], v[80:83], v[140:143]
  ds_read_b64_tr_b16 v[192:193], v106 offset:7680
  v_mfma_f32_16x16x32_bf16 v[168:171], v[196:199], v[84:87], v[168:171]
  ds_read_b64_tr_b16 v[194:195], v106 offset:8640
  s_waitcnt lgkmcnt(10)
  v_mfma_f32_16x16x32_bf16 v[144:147], v[200:203], v[80:83], v[144:147]
  ds_read_b64_tr_b16 v[196:197], v106 offset:7712
  ds_read_b128 v[88:91], v101 offset:0
  v_mfma_f32_16x16x32_bf16 v[172:175], v[200:203], v[84:87], v[172:175]
  ds_read_b64_tr_b16 v[198:199], v106 offset:8672
  ds_read_b128 v[92:95], v101 offset:2048
  s_waitcnt lgkmcnt(12)
  v_mfma_f32_16x16x32_bf16 v[148:151], v[204:207], v[80:83], v[148:151]
  ds_read_b64_tr_b16 v[200:201], v106 offset:7744
  v_mfma_f32_16x16x32_bf16 v[176:179], v[204:207], v[84:87], v[176:179]
  ds_read_b64_tr_b16 v[202:203], v106 offset:8704
  s_waitcnt lgkmcnt(12)
  v_mfma_f32_16x16x32_bf16 v[152:155], v[208:211], v[80:83], v[152:155]
  ds_read_b64_tr_b16 v[204:205], v106 offset:7776
  v_mfma_f32_16x16x32_bf16 v[180:183], v[208:211], v[84:87], v[180:183]
  ds_read_b64_tr_b16 v[206:207], v106 offset:8736
  s_add_u32 s93, s90, 4096
  buffer_store_dwordx4 v[8:11], v18, s[40:43], s90 offen sc1
  buffer_store_dwordx4 v[12:15], v18, s[40:43], s93 offen sc1
  s_mov_b32 exec_lo, 0
  s_mov_b32 exec_hi, 0x80000000
  buffer_store_dwordx2 v[16:17], v19, s[40:43], s91 offen sc1
  s_mov_b64 exec, -1
  s_waitcnt lgkmcnt(12)
  v_mfma_f32_16x16x32_bf16 v[156:159], v[212:215], v[80:83], v[156:159]
  ds_read_b64_tr_b16 v[208:209], v106 offset:7808
  v_mfma_f32_16x16x32_bf16 v[184:187], v[212:215], v[84:87], v[184:187]
  ds_read_b64_tr_b16 v[210:211], v106 offset:8768
  s_waitcnt lgkmcnt(12)
  v_mfma_f32_16x16x32_bf16 v[160:163], v[216:219], v[80:83], v[160:163]
  ds_read_b64_tr_b16 v[212:213], v106 offset:7840
  v_mfma_f32_16x16x32_bf16 v[188:191], v[216:219], v[84:87], v[188:191]
  ds_read_b64_tr_b16 v[214:215], v106 offset:8800
  s_waitcnt lgkmcnt(8)
  v_mfma_f32_16x16x32_bf16 v[136:139], v[192:195], v[88:91], v[136:139]
  ds_read_b64_tr_b16 v[216:217], v107 offset:7680
  v_mfma_f32_16x16x32_bf16 v[164:167], v[192:195], v[92:95], v[164:167]
  ds_read_b64_tr_b16 v[218:219], v107 offset:8640
  s_waitcnt lgkmcnt(10)
  v_mfma_f32_16x16x32_bf16 v[140:143], v[196:199], v[88:91], v[140:143]
  s_barrier
  ds_read_b64_tr_b16 v[192:193], v102 offset:0
  v_mfma_f32_16x16x32_bf16 v[168:171], v[196:199], v[92:95], v[168:171]
  ds_read_b64_tr_b16 v[194:195], v102 offset:960
  s_waitcnt lgkmcnt(10)
  v_mfma_f32_16x16x32_bf16 v[144:147], v[200:203], v[88:91], v[144:147]
  ds_read_b64_tr_b16 v[196:197], v102 offset:32
  ds_read_b128 v[80:83], v96 offset:0
  v_mfma_f32_16x16x32_bf16 v[172:175], v[200:203], v[92:95], v[172:175]
  ds_read_b64_tr_b16 v[198:199], v102 offset:992
  ds_read_b128 v[84:87], v96 offset:2048
  s_waitcnt lgkmcnt(12)
  v_mfma_f32_16x16x32_bf16 v[148:151], v[204:207], v[88:91], v[148:151]
  ds_read_b64_tr_b16 v[200:201], v102 offset:64
  v_mfma_f32_16x16x32_bf16 v[176:179], v[204:207], v[92:95], v[176:179]
  ds_read_b64_tr_b16 v[202:203], v102 offset:1024
  s_waitcnt lgkmcnt(12)
  v_mfma_f32_16x16x32_bf16 v[152:155], v[208:211], v[88:91], v[152:155]
  ds_read_b64_tr_b16 v[204:205], v102 offset:96
  v_mfma_f32_16x16x32_bf16 v[180:183], v[208:211], v[92:95], v[180:183]
  ds_read_b64_tr_b16 v[206:207], v102 offset:1056
  s_waitcnt lgkmcnt(12)
  v_mfma_f32_16x16x32_bf16 v[156:159], v[212:215], v[88:91], v[156:159]
  ds_read_b64_tr_b16 v[208:209], v102 offset:128
  v_mfma_f32_16x16x32_bf16 v[184:187], v[212:215], v[92:95], v[184:187]
  ds_read_b64_tr_b16 v[210:211], v102 offset:1088
  s_waitcnt lgkmcnt(12)
  v_mfma_f32_16x16x32_bf16 v[160:163], v[216:219], v[88:91], v[160:163]
  ds_read_b64_tr_b16 v[212:213], v102 offset:160
  v_mfma_f32_16x16x32_bf16 v[188:191], v[216:219], v[92:95], v[188:191]
  ds_read_b64_tr_b16 v[214:215], v102 offset:1120
  s_waitcnt lgkmcnt(8)
  v_mfma_f32_16x16x32_bf16 v[136:139], v[192:195], v[80:83], v[136:139]
  ds_read_b64_tr_b16 v[216:217], v103 offset:0
  v_mfma_f32_16x16x32_bf16 v[164:167], v[192:195], v[84:87], v[164:167]
  ds_read_b64_tr_b16 v[218:219], v103 offset:960
  s_waitcnt lgkmcnt(10)
  v_mfma_f32_16x16x32_bf16 v[140:143], v[196:199], v[80:83], v[140:143]
  ds_read_b64_tr_b16 v[192:193], v102 offset:7680
  v_mfma_f32_16x16x32_bf16 v[168:171], v[196:199], v[84:87], v[168:171]
  ds_read_b64_tr_b16 v[194:195], v102 offset:8640
  s_waitcnt lgkmcnt(10)
  v_mfma_f32_16x16x32_bf16 v[144:147], v[200:203], v[80:83], v[144:147]
  ds_read_b64_tr_b16 v[196:197], v102 offset:7712
  ds_read_b128 v[88:91], v97 offset:0
  v_mfma_f32_16x16x32_bf16 v[172:175], v[200:203], v[84:87], v[172:175]
  ds_read_b64_tr_b16 v[198:199], v102 offset:8672
  ds_read_b128 v[92:95], v97 offset:2048
  s_waitcnt lgkmcnt(12)
  v_mfma_f32_16x16x32_bf16 v[148:151], v[204:207], v[80:83], v[148:151]
  ds_read_b64_tr_b16 v[200:201], v102 offset:7744
  v_mfma_f32_16x16x32_bf16 v[176:179], v[204:207], v[84:87], v[176:179]
  ds_read_b64_tr_b16 v[202:203], v102 offset:8704
  s_waitcnt lgkmcnt(12)
  v_mfma_f32_16x16x32_bf16 v[152:155], v[208:211], v[80:83], v[152:155]
  ds_read_b64_tr_b16 v[204:205], v102 offset:7776
  v_mfma_f32_16x16x32_bf16 v[180:183], v[208:211], v[84:87], v[180:183]
  ds_read_b64_tr_b16 v[206:207], v102 offset:8736
  s_waitcnt lgkmcnt(12)
  v_mfma_f32_16x16x32_bf16 v[156:159], v[212:215], v[80:83], v[156:159]
  ds_read_b64_tr_b16 v[208:209], v102 offset:7808
  v_mfma_f32_16x16x32_bf16 v[184:187], v[212:215], v[84:87], v[184:187]
  ds_read_b64_tr_b16 v[210:211], v102 offset:8768
  s_waitcnt lgkmcnt(12)
  v_mfma_f32_16x16x32_bf16 v[160:163], v[216:219], v[80:83], v[160:163]
  ds_read_b64_tr_b16 v[212:213], v102 offset:7840
  v_mfma_f32_16x16x32_bf16 v[188:191], v[216:219], v[84:87], v[188:191]
  ds_read_b64_tr_b16 v[214:215], v102 offset:8800
  s_waitcnt lgkmcnt(8)
  v_mfma_f32_16x16x32_bf16 v[136:139], v[192:195], v[88:91], v[136:139]
  ds_read_b64_tr_b16 v[216:217], v103 offset:7680
  v_mfma_f32_16x16x32_bf16 v[164:167], v[192:195], v[92:95], v[164:167]
  ds_read_b64_tr_b16 v[218:219], v103 offset:8640
  s_waitcnt lgkmcnt(10)
  v_mfma_f32_16x16x32_bf16 v[140:143], v[196:199], v[88:91], v[140:143]
  s_barrier
  ds_read_b64_tr_b16 v[192:193], v102 offset:31744
  v_mfma_f32_16x16x32_bf16 v[168:171], v[196:199], v[92:95], v[168:171]
  ds_read_b64_tr_b16 v[194:195], v102 offset:32704
  s_waitcnt lgkmcnt(10)
  v_mfma_f32_16x16x32_bf16 v[144:147], v[200:203], v[88:91], v[144:147]
  ds_read_b64_tr_b16 v[196:197], v102 offset:31776
  ds_read_b128 v[80:83], v96 offset:31744
  v_mfma_f32_16x16x32_bf16 v[172:175], v[200:203], v[92:95], v[172:175]
  ds_read_b64_tr_b16 v[198:199], v102 offset:32736
  ds_read_b128 v[84:87], v96 offset:33792
  s_waitcnt lgkmcnt(12)
  v_mfma_f32_16x16x32_bf16 v[148:151], v[204:207], v[88:91], v[148:151]
  ds_read_b64_tr_b16 v[200:201], v102 offset:31808
  v_mfma_f32_16x16x32_bf16 v[176:179], v[204:207], v[92:95], v[176:179]
  ds_read_b64_tr_b16 v[202:203], v102 offset:32768
  s_waitcnt lgkmcnt(12)
  v_mfma_f32_16x16x32_bf16 v[152:155], v[208:211], v[88:91], v[152:155]
  ds_read_b64_tr_b16 v[204:205], v102 offset:31840
  v_mfma_f32_16x16x32_bf16 v[180:183], v[208:211], v[92:95], v[180:183]
  ds_read_b64_tr_b16 v[206:207], v102 offset:32800
  s_waitcnt lgkmcnt(12)
  v_mfma_f32_16x16x32_bf16 v[156:159], v[212:215], v[88:91], v[156:159]
  ds_read_b64_tr_b16 v[208:209], v102 offset:31872
  v_mfma_f32_16x16x32_bf16 v[184:187], v[212:215], v[92:95], v[184:187]
  ds_read_b64_tr_b16 v[210:211], v102 offset:32832
  s_waitcnt lgkmcnt(12)
  v_mfma_f32_16x16x32_bf16 v[160:163], v[216:219], v[88:91], v[160:163]
  ds_read_b64_tr_b16 v[212:213], v102 offset:31904
  v_mfma_f32_16x16x32_bf16 v[188:191], v[216:219], v[92:95], v[188:191]
  ds_read_b64_tr_b16 v[214:215], v102 offset:32864
  s_waitcnt lgkmcnt(8)
  v_mfma_f32_16x16x32_bf16 v[136:139], v[192:195], v[80:83], v[136:139]
  ds_read_b64_tr_b16 v[216:217], v103 offset:31744
  v_mfma_f32_16x16x32_bf16 v[164:167], v[192:195], v[84:87], v[164:167]
  ds_read_b64_tr_b16 v[218:219], v103 offset:32704
  s_waitcnt lgkmcnt(10)
  v_mfma_f32_16x16x32_bf16 v[140:143], v[196:199], v[80:83], v[140:143]
  ds_read_b64_tr_b16 v[192:193], v102 offset:39424
  v_mfma_f32_16x16x32_bf16 v[168:171], v[196:199], v[84:87], v[168:171]
  ds_read_b64_tr_b16 v[194:195], v102 offset:40384
  s_waitcnt lgkmcnt(10)
  v_mfma_f32_16x16x32_bf16 v[144:147], v[200:203], v[80:83], v[144:147]
  ds_read_b64_tr_b16 v[196:197], v102 offset:39456
  ds_read_b128 v[88:91], v97 offset:31744
  v_mfma_f32_16x16x32_bf16 v[172:175], v[200:203], v[84:87], v[172:175]
  ds_read_b64_tr_b16 v[198:199], v102 offset:40416
  ds_read_b128 v[92:95], v97 offset:33792
  s_waitcnt lgkmcnt(12)
  v_mfma_f32_16x16x32_bf16 v[148:151], v[204:207], v[80:83], v[148:151]
  ds_read_b64_tr_b16 v[200:201], v102 offset:39488
  v_mfma_f32_16x16x32_bf16 v[176:179], v[204:207], v[84:87], v[176:179]
  ds_read_b64_tr_b16 v[202:203], v102 offset:40448
  s_waitcnt lgkmcnt(12)
  v_mfma_f32_16x16x32_bf16 v[152:155], v[208:211], v[80:83], v[152:155]
  ds_read_b64_tr_b16 v[204:205], v102 offset:39520
  v_mfma_f32_16x16x32_bf16 v[180:183], v[208:211], v[84:87], v[180:183]
  ds_read_b64_tr_b16 v[206:207], v102 offset:40480
  s_waitcnt lgkmcnt(12)
  v_mfma_f32_16x16x32_bf16 v[156:159], v[212:215], v[80:83], v[156:159]
  ds_read_b64_tr_b16 v[208:209], v102 offset:39552
  v_mfma_f32_16x16x32_bf16 v[184:187], v[212:215], v[84:87], v[184:187]
  ds_read_b64_tr_b16 v[210:211], v102 offset:40512
  s_waitcnt lgkmcnt(12)
  v_mfma_f32_16x16x32_bf16 v[160:163], v[216:219], v[80:83], v[160:163]
  ds_read_b64_tr_b16 v[212:213], v102 offset:39584
  v_mfma_f32_16x16x32_bf16 v[188:191], v[216:219], v[84:87], v[188:191]
  ds_read_b64_tr_b16 v[214:215], v102 offset:40544
  s_waitcnt lgkmcnt(8)
  v_mfma_f32_16x16x32_bf16 v[136:139], v[192:195], v[88:91], v[136:139]
  ds_read_b64_tr_b16 v[216:217], v103 offset:39424
  v_mfma_f32_16x16x32_bf16 v[164:167], v[192:195], v[92:95], v[164:167]
  ds_read_b64_tr_b16 v[218:219], v103 offset:40384
  s_waitcnt lgkmcnt(10)
  v_mfma_f32_16x16x32_bf16 v[140:143], v[196:199], v[88:91], v[140:143]
  s_waitcnt vmcnt(0)
  s_barrier
  ds_read_b64_tr_b16 v[192:193], v104 offset:0
  v_mfma_f32_16x16x32_bf16 v[168:171], v[196:199], v[92:95], v[168:171]
  ds_read_b64_tr_b16 v[194:195], v104 offset:960
  s_waitcnt lgkmcnt(10)
  v_mfma_f32_16x16x32_bf16 v[144:147], v[200:203], v[88:91], v[144:147]
  ds_read_b64_tr_b16 v[196:197], v104 offset:32
  ds_read_b128 v[80:83], v98 offset:0
  v_mfma_f32_16x16x32_bf16 v[172:175], v[200:203], v[92:95], v[172:175]
  ds_read_b64_tr_b16 v[198:199], v104 offset:992
  ds_read_b128 v[84:87], v98 offset:2048
  s_waitcnt lgkmcnt(12)
  v_mfma_f32_16x16x32_bf16 v[148:151], v[204:207], v[88:91], v[148:151]
  ds_read_b64_tr_b16 v[200:201], v104 offset:64
  v_mfma_f32_16x16x32_bf16 v[176:179], v[204:207], v[92:95], v[176:179]
  ds_read_b64_tr_b16 v[202:203], v104 offset:1024
  s_waitcnt lgkmcnt(12)
  v_mfma_f32_16x16x32_bf16 v[152:155], v[208:211], v[88:91], v[152:155]
  ds_read_b64_tr_b16 v[204:205], v104 offset:96
  v_mfma_f32_16x16x32_bf16 v[180:183], v[208:211], v[92:95], v[180:183]
  ds_read_b64_tr_b16 v[206:207], v104 offset:1056
  s_waitcnt lgkmcnt(12)
  v_mfma_f32_16x16x32_bf16 v[156:159], v[212:215], v[88:91], v[156:159]
  ds_read_b64_tr_b16 v[208:209], v104 offset:128
  v_mfma_f32_16x16x32_bf16 v[184:187], v[212:215], v[92:95], v[184:187]
  ds_read_b64_tr_b16 v[210:211], v104 offset:1088
  s_waitcnt lgkmcnt(12)
  v_mfma_f32_16x16x32_bf16 v[160:163], v[216:219], v[88:91], v[160:163]
  ds_read_b64_tr_b16 v[212:213], v104 offset:160
  v_mfma_f32_16x16x32_bf16 v[188:191], v[216:219], v[92:95], v[188:191]
  ds_read_b64_tr_b16 v[214:215], v104 offset:1120
  s_waitcnt lgkmcnt(8)
  v_mfma_f32_16x16x32_bf16 v[136:139], v[192:195], v[80:83], v[136:139]
  ds_read_b64_tr_b16 v[216:217], v105 offset:0
  v_mfma_f32_16x16x32_bf16 v[164:167], v[192:195], v[84:87], v[164:167]
  ds_read_b64_tr_b16 v[218:219], v105 offset:960
  s_waitcnt lgkmcnt(10)
  v_mfma_f32_16x16x32_bf16 v[140:143], v[196:199], v[80:83], v[140:143]
  ds_read_b64_tr_b16 v[192:193], v104 offset:7680
  v_mfma_f32_16x16x32_bf16 v[168:171], v[196:199], v[84:87], v[168:171]
  ds_read_b64_tr_b16 v[194:195], v104 offset:8640
  s_waitcnt lgkmcnt(10)
  v_mfma_f32_16x16x32_bf16 v[144:147], v[200:203], v[80:83], v[144:147]
  ds_read_b64_tr_b16 v[196:197], v104 offset:7712
  ds_read_b128 v[88:91], v99 offset:0
  v_mfma_f32_16x16x32_bf16 v[172:175], v[200:203], v[84:87], v[172:175]
  ds_read_b64_tr_b16 v[198:199], v104 offset:8672
  ds_read_b128 v[92:95], v99 offset:2048
  s_waitcnt lgkmcnt(12)
  v_mfma_f32_16x16x32_bf16 v[148:151], v[204:207], v[80:83], v[148:151]
  ds_read_b64_tr_b16 v[200:201], v104 offset:7744
  v_mfma_f32_16x16x32_bf16 v[176:179], v[204:207], v[84:87], v[176:179]
  ds_read_b64_tr_b16 v[202:203], v104 offset:8704
  s_waitcnt lgkmcnt(12)
  v_mfma_f32_16x16x32_bf16 v[152:155], v[208:211], v[80:83], v[152:155]
  ds_read_b64_tr_b16 v[204:205], v104 offset:7776
  v_mfma_f32_16x16x32_bf16 v[180:183], v[208:211], v[84:87], v[180:183]
  ds_read_b64_tr_b16 v[206:207], v104 offset:8736
  s_waitcnt lgkmcnt(12)
  v_mfma_f32_16x16x32_bf16 v[156:159], v[212:215], v[80:83], v[156:159]
  ds_read_b64_tr_b16 v[208:209], v104 offset:7808
  v_mfma_f32_16x16x32_bf16 v[184:187], v[212:215], v[84:87], v[184:187]
  ds_read_b64_tr_b16 v[210:211], v104 offset:8768
  s_waitcnt lgkmcnt(12)
  v_mfma_f32_16x16x32_bf16 v[160:163], v[216:219], v[80:83], v[160:163]
  ds_read_b64_tr_b16 v[212:213], v104 offset:7840
  v_mfma_f32_16x16x32_bf16 v[188:191], v[216:219], v[84:87], v[188:191]
  ds_read_b64_tr_b16 v[214:215], v104 offset:8800
  s_waitcnt lgkmcnt(8)
  v_mfma_f32_16x16x32_bf16 v[136:139], v[192:195], v[88:91], v[136:139]
  ds_read_b64_tr_b16 v[216:217], v105 offset:7680
  v_mfma_f32_16x16x32_bf16 v[164:167], v[192:195], v[92:95], v[164:167]
  ds_read_b64_tr_b16 v[218:219], v105 offset:8640
  s_waitcnt lgkmcnt(10)
  v_mfma_f32_16x16x32_bf16 v[140:143], v[196:199], v[88:91], v[140:143]
  v_mfma_f32_16x16x32_bf16 v[168:171], v[196:199], v[92:95], v[168:171]
  s_waitcnt lgkmcnt(8)
  v_mfma_f32_16x16x32_bf16 v[144:147], v[200:203], v[88:91], v[144:147]
  v_mfma_f32_16x16x32_bf16 v[172:175], v[200:203], v[92:95], v[172:175]
  s_waitcnt lgkmcnt(6)
  v_mfma_f32_16x16x32_bf16 v[148:151], v[204:207], v[88:91], v[148:151]
  v_mfma_f32_16x16x32_bf16 v[176:179], v[204:207], v[92:95], v[176:179]
  s_waitcnt lgkmcnt(4)
  v_mfma_f32_16x16x32_bf16 v[152:155], v[208:211], v[88:91], v[152:155]
  v_mfma_f32_16x16x32_bf16 v[180:183], v[208:211], v[92:95], v[180:183]
  s_waitcnt lgkmcnt(2)
  v_mfma_f32_16x16x32_bf16 v[156:159], v[212:215], v[88:91], v[156:159]
  v_mfma_f32_16x16x32_bf16 v[184:187], v[212:215], v[92:95], v[184:187]
  s_waitcnt lgkmcnt(0)
  v_mfma_f32_16x16x32_bf16 v[160:163], v[216:219], v[88:91], v[160:163]
  v_mfma_f32_16x16x32_bf16 v[188:191], v[216:219], v[92:95], v[188:191]
  s_barrier
  s_mov_b32 s84, 0x3fb8aa3b
  s_mov_b32 s85, 0x3fb8aa3b
  s_mov_b32 s86, 0x41f00000
  s_mul_i32 s87, s7, 7
  s_add_u32 s87, s87, s48
  s_lshr_b32 s87, s87, 1
  s_lshl_b32 s87, s87, 12
  s_mul_i32 s88, s6, 458752
  s_lshl_b32 s89, s3, 10
  s_add_u32 s88, s88, s89
  s_add_u32 s88, s88, 8388608
  s_add_u32 s88, s88, s87
  s_mov_b32 s89, 12288
  s_cmp_eq_u32 s48, 0
  s_cselect_b32 s89, s89, 4294963712
  s_add_u32 s89, s89, s88
  v_lshlrev_b32 v4, 3, v0
  v_pk_mul_f32 v[192:193], v[136:137], s[84:85]
  v_pk_mul_f32 v[196:197], v[138:139], s[84:85]
  v_pk_mul_f32 v[200:201], v[140:141], s[84:85]
  v_pk_mul_f32 v[204:205], v[142:143], s[84:85]
  v_min_f32 v192, s86, v192
  v_min_f32 v193, s86, v193
  v_min_f32 v196, s86, v196
  v_min_f32 v197, s86, v197
  v_min_f32 v200, s86, v200
  v_min_f32 v201, s86, v201
  v_min_f32 v204, s86, v204
  v_min_f32 v205, s86, v205
  v_exp_f32 v192, v192
  v_exp_f32 v193, v193
  v_exp_f32 v196, v196
  v_exp_f32 v197, v197
  v_exp_f32 v200, v200
  v_exp_f32 v201, v201
  v_exp_f32 v204, v204
  v_exp_f32 v205, v205
  v_pk_add_f32 v[194:195], v[192:193], 2.0 op_sel_hi:[1,0]
  v_pk_add_f32 v[198:199], v[196:197], 2.0 op_sel_hi:[1,0]
  v_pk_add_f32 v[202:203], v[200:201], 2.0 op_sel_hi:[1,0]
  v_pk_add_f32 v[206:207], v[204:205], 2.0 op_sel_hi:[1,0]
  v_pk_mul_f32 v[192:193], v[192:193], v[194:195]
  v_pk_mul_f32 v[196:197], v[196:197], v[198:199]
  v_pk_mul_f32 v[200:201], v[200:201], v[202:203]
  v_pk_mul_f32 v[204:205], v[204:205], v[206:207]
  v_pk_add_f32 v[194:195], v[192:193], 2.0 op_sel_hi:[1,0]
  v_pk_add_f32 v[198:199], v[196:197], 2.0 op_sel_hi:[1,0]
  v_pk_add_f32 v[202:203], v[200:201], 2.0 op_sel_hi:[1,0]
  v_pk_add_f32 v[206:207], v[204:205], 2.0 op_sel_hi:[1,0]
  v_rcp_f32 v194, v194
  v_rcp_f32 v195, v195
  v_rcp_f32 v198, v198
  v_rcp_f32 v199, v199
  v_rcp_f32 v202, v202
  v_rcp_f32 v203, v203
  v_rcp_f32 v206, v206
  v_rcp_f32 v207, v207
  v_pk_mul_f32 v[192:193], v[192:193], v[194:195]
  v_pk_mul_f32 v[196:197], v[196:197], v[198:199]
  v_pk_mul_f32 v[200:201], v[200:201], v[202:203]
  v_pk_mul_f32 v[204:205], v[204:205], v[206:207]
  v_pk_mul_f32 v[192:193], v[192:193], v[136:137]
  v_pk_mul_f32 v[196:197], v[196:197], v[138:139]
  v_pk_mul_f32 v[200:201], v[200:201], v[140:141]
  v_pk_mul_f32 v[204:205], v[204:205], v[142:143]
  v_cvt_pk_bf16_f32 v108, v192, v193
  v_cvt_pk_bf16_f32 v109, v196, v197
  v_cvt_pk_bf16_f32 v110, v200, v201
  v_cvt_pk_bf16_f32 v111, v204, v205
  buffer_store_dwordx4 v[108:111], v3, s[40:43], s88 offen sc1
  s_add_u32 s88, s88, 4096
  v_pk_mul_f32 v[192:193], v[144:145], s[84:85]
  v_pk_mul_f32 v[196:197], v[146:147], s[84:85]
  v_pk_mul_f32 v[200:201], v[148:149], s[84:85]
  v_pk_mul_f32 v[204:205], v[150:151], s[84:85]
  v_min_f32 v192, s86, v192
  v_min_f32 v193, s86, v193
  v_min_f32 v196, s86, v196
  v_min_f32 v197, s86, v197
  v_min_f32 v200, s86, v200
  v_min_f32 v201, s86, v201
  v_min_f32 v204, s86, v204
  v_min_f32 v205, s86, v205
  v_exp_f32 v192, v192
  v_exp_f32 v193, v193
  v_exp_f32 v196, v196
  v_exp_f32 v197, v197
  v_exp_f32 v200, v200
  v_exp_f32 v201, v201
  v_exp_f32 v204, v204
  v_exp_f32 v205, v205
  v_pk_add_f32 v[194:195], v[192:193], 2.0 op_sel_hi:[1,0]
  v_pk_add_f32 v[198:199], v[196:197], 2.0 op_sel_hi:[1,0]
  v_pk_add_f32 v[202:203], v[200:201], 2.0 op_sel_hi:[1,0]
  v_pk_add_f32 v[206:207], v[204:205], 2.0 op_sel_hi:[1,0]
  v_pk_mul_f32 v[192:193], v[192:193], v[194:195]
  v_pk_mul_f32 v[196:197], v[196:197], v[198:199]
  v_pk_mul_f32 v[200:201], v[200:201], v[202:203]
  v_pk_mul_f32 v[204:205], v[204:205], v[206:207]
  v_pk_add_f32 v[194:195], v[192:193], 2.0 op_sel_hi:[1,0]
  v_pk_add_f32 v[198:199], v[196:197], 2.0 op_sel_hi:[1,0]
  v_pk_add_f32 v[202:203], v[200:201], 2.0 op_sel_hi:[1,0]
  v_pk_add_f32 v[206:207], v[204:205], 2.0 op_sel_hi:[1,0]
  v_rcp_f32 v194, v194
  v_rcp_f32 v195, v195
  v_rcp_f32 v198, v198
  v_rcp_f32 v199, v199
  v_rcp_f32 v202, v202
  v_rcp_f32 v203, v203
  v_rcp_f32 v206, v206
  v_rcp_f32 v207, v207
  v_pk_mul_f32 v[192:193], v[192:193], v[194:195]
  v_pk_mul_f32 v[196:197], v[196:197], v[198:199]
  v_pk_mul_f32 v[200:201], v[200:201], v[202:203]
  v_pk_mul_f32 v[204:205], v[204:205], v[206:207]
  v_pk_mul_f32 v[192:193], v[192:193], v[144:145]
  v_pk_mul_f32 v[196:197], v[196:197], v[146:147]
  v_pk_mul_f32 v[200:201], v[200:201], v[148:149]
  v_pk_mul_f32 v[204:205], v[204:205], v[150:151]
  v_cvt_pk_bf16_f32 v112, v192, v193
  v_cvt_pk_bf16_f32 v113, v196, v197
  v_cvt_pk_bf16_f32 v114, v200, v201
  v_cvt_pk_bf16_f32 v115, v204, v205
  buffer_store_dwordx4 v[112:115], v3, s[40:43], s88 offen sc1
  s_add_u32 s88, s88, 4096
  v_pk_mul_f32 v[192:193], v[152:153], s[84:85]
  v_pk_mul_f32 v[196:197], v[154:155], s[84:85]
  v_pk_mul_f32 v[200:201], v[156:157], s[84:85]
  v_pk_mul_f32 v[204:205], v[158:159], s[84:85]
  v_min_f32 v192, s86, v192
  v_min_f32 v193, s86, v193
  v_min_f32 v196, s86, v196
  v_min_f32 v197, s86, v197
  v_min_f32 v200, s86, v200
  v_min_f32 v201, s86, v201
  v_min_f32 v204, s86, v204
  v_min_f32 v205, s86, v205
  v_exp_f32 v192, v192
  v_exp_f32 v193, v193
  v_exp_f32 v196, v196
  v_exp_f32 v197, v197
  v_exp_f32 v200, v200
  v_exp_f32 v201, v201
  v_exp_f32 v204, v204
  v_exp_f32 v205, v205
  v_pk_add_f32 v[194:195], v[192:193], 2.0 op_sel_hi:[1,0]
  v_pk_add_f32 v[198:199], v[196:197], 2.0 op_sel_hi:[1,0]
  v_pk_add_f32 v[202:203], v[200:201], 2.0 op_sel_hi:[1,0]
  v_pk_add_f32 v[206:207], v[204:205], 2.0 op_sel_hi:[1,0]
  v_pk_mul_f32 v[192:193], v[192:193], v[194:195]
  v_pk_mul_f32 v[196:197], v[196:197], v[198:199]
  v_pk_mul_f32 v[200:201], v[200:201], v[202:203]
  v_pk_mul_f32 v[204:205], v[204:205], v[206:207]
  v_pk_add_f32 v[194:195], v[192:193], 2.0 op_sel_hi:[1,0]
  v_pk_add_f32 v[198:199], v[196:197], 2.0 op_sel_hi:[1,0]
  v_pk_add_f32 v[202:203], v[200:201], 2.0 op_sel_hi:[1,0]
  v_pk_add_f32 v[206:207], v[204:205], 2.0 op_sel_hi:[1,0]
  v_rcp_f32 v194, v194
  v_rcp_f32 v195, v195
  v_rcp_f32 v198, v198
  v_rcp_f32 v199, v199
  v_rcp_f32 v202, v202
  v_rcp_f32 v203, v203
  v_rcp_f32 v206, v206
  v_rcp_f32 v207, v207
  v_pk_mul_f32 v[192:193], v[192:193], v[194:195]
  v_pk_mul_f32 v[196:197], v[196:197], v[198:199]
  v_pk_mul_f32 v[200:201], v[200:201], v[202:203]
  v_pk_mul_f32 v[204:205], v[204:205], v[206:207]
  v_pk_mul_f32 v[192:193], v[192:193], v[152:153]
  v_pk_mul_f32 v[196:197], v[196:197], v[154:155]
  v_pk_mul_f32 v[200:201], v[200:201], v[156:157]
  v_pk_mul_f32 v[204:205], v[204:205], v[158:159]
  v_cvt_pk_bf16_f32 v116, v192, v193
  v_cvt_pk_bf16_f32 v117, v196, v197
  v_cvt_pk_bf16_f32 v118, v200, v201
  v_cvt_pk_bf16_f32 v119, v204, v205
  buffer_store_dwordx4 v[116:119], v3, s[40:43], s88 offen sc1
  s_add_u32 s88, s88, 4096
  v_pk_mul_f32 v[192:193], v[160:161], s[84:85]
  v_pk_mul_f32 v[196:197], v[162:163], s[84:85]
  v_min_f32 v192, s86, v192
  v_min_f32 v193, s86, v193
  v_min_f32 v196, s86, v196
  v_min_f32 v197, s86, v197
  v_exp_f32 v192, v192
  v_exp_f32 v193, v193
  v_exp_f32 v196, v196
  v_exp_f32 v197, v197
  v_pk_add_f32 v[194:195], v[192:193], 2.0 op_sel_hi:[1,0]
  v_pk_add_f32 v[198:199], v[196:197], 2.0 op_sel_hi:[1,0]
  v_pk_mul_f32 v[192:193], v[192:193], v[194:195]
  v_pk_mul_f32 v[196:197], v[196:197], v[198:199]
  v_pk_add_f32 v[194:195], v[192:193], 2.0 op_sel_hi:[1,0]
  v_pk_add_f32 v[198:199], v[196:197], 2.0 op_sel_hi:[1,0]
  v_rcp_f32 v194, v194
  v_rcp_f32 v195, v195
  v_rcp_f32 v198, v198
  v_rcp_f32 v199, v199
  v_pk_mul_f32 v[192:193], v[192:193], v[194:195]
  v_pk_mul_f32 v[196:197], v[196:197], v[198:199]
  v_pk_mul_f32 v[192:193], v[192:193], v[160:161]
  v_pk_mul_f32 v[196:197], v[196:197], v[162:163]
  v_cvt_pk_bf16_f32 v120, v192, v193
  v_cvt_pk_bf16_f32 v121, v196, v197
  buffer_store_dwordx2 v[120:121], v4, s[40:43], s89 offen sc1
  s_add_u32 s88, s88, 217088
  s_add_u32 s89, s89, 229376
  v_pk_mul_f32 v[192:193], v[164:165], s[84:85]
  v_pk_mul_f32 v[196:197], v[166:167], s[84:85]
  v_pk_mul_f32 v[200:201], v[168:169], s[84:85]
  v_pk_mul_f32 v[204:205], v[170:171], s[84:85]
  v_min_f32 v192, s86, v192
  v_min_f32 v193, s86, v193
  v_min_f32 v196, s86, v196
  v_min_f32 v197, s86, v197
  v_min_f32 v200, s86, v200
  v_min_f32 v201, s86, v201
  v_min_f32 v204, s86, v204
  v_min_f32 v205, s86, v205
  v_exp_f32 v192, v192
  v_exp_f32 v193, v193
  v_exp_f32 v196, v196
  v_exp_f32 v197, v197
  v_exp_f32 v200, v200
  v_exp_f32 v201, v201
  v_exp_f32 v204, v204
  v_exp_f32 v205, v205
  v_pk_add_f32 v[194:195], v[192:193], 2.0 op_sel_hi:[1,0]
  v_pk_add_f32 v[198:199], v[196:197], 2.0 op_sel_hi:[1,0]
  v_pk_add_f32 v[202:203], v[200:201], 2.0 op_sel_hi:[1,0]
  v_pk_add_f32 v[206:207], v[204:205], 2.0 op_sel_hi:[1,0]
  v_pk_mul_f32 v[192:193], v[192:193], v[194:195]
  v_pk_mul_f32 v[196:197], v[196:197], v[198:199]
  v_pk_mul_f32 v[200:201], v[200:201], v[202:203]
  v_pk_mul_f32 v[204:205], v[204:205], v[206:207]
  v_pk_add_f32 v[194:195], v[192:193], 2.0 op_sel_hi:[1,0]
  v_pk_add_f32 v[198:199], v[196:197], 2.0 op_sel_hi:[1,0]
  v_pk_add_f32 v[202:203], v[200:201], 2.0 op_sel_hi:[1,0]
  v_pk_add_f32 v[206:207], v[204:205], 2.0 op_sel_hi:[1,0]
  v_rcp_f32 v194, v194
  v_rcp_f32 v195, v195
  v_rcp_f32 v198, v198
  v_rcp_f32 v199, v199
  v_rcp_f32 v202, v202
  v_rcp_f32 v203, v203
  v_rcp_f32 v206, v206
  v_rcp_f32 v207, v207
  v_pk_mul_f32 v[192:193], v[192:193], v[194:195]
  v_pk_mul_f32 v[196:197], v[196:197], v[198:199]
  v_pk_mul_f32 v[200:201], v[200:201], v[202:203]
  v_pk_mul_f32 v[204:205], v[204:205], v[206:207]
  v_pk_mul_f32 v[192:193], v[192:193], v[164:165]
  v_pk_mul_f32 v[196:197], v[196:197], v[166:167]
  v_pk_mul_f32 v[200:201], v[200:201], v[168:169]
  v_pk_mul_f32 v[204:205], v[204:205], v[170:171]
  v_cvt_pk_bf16_f32 v122, v192, v193
  v_cvt_pk_bf16_f32 v123, v196, v197
  v_cvt_pk_bf16_f32 v124, v200, v201
  v_cvt_pk_bf16_f32 v125, v204, v205
  buffer_store_dwordx4 v[122:125], v3, s[40:43], s88 offen sc1
  s_add_u32 s88, s88, 4096
  v_pk_mul_f32 v[192:193], v[172:173], s[84:85]
  v_pk_mul_f32 v[196:197], v[174:175], s[84:85]
  v_pk_mul_f32 v[200:201], v[176:177], s[84:85]
  v_pk_mul_f32 v[204:205], v[178:179], s[84:85]
  v_min_f32 v192, s86, v192
  v_min_f32 v193, s86, v193
  v_min_f32 v196, s86, v196
  v_min_f32 v197, s86, v197
  v_min_f32 v200, s86, v200
  v_min_f32 v201, s86, v201
  v_min_f32 v204, s86, v204
  v_min_f32 v205, s86, v205
  v_exp_f32 v192, v192
  v_exp_f32 v193, v193
  v_exp_f32 v196, v196
  v_exp_f32 v197, v197
  v_exp_f32 v200, v200
  v_exp_f32 v201, v201
  v_exp_f32 v204, v204
  v_exp_f32 v205, v205
  v_pk_add_f32 v[194:195], v[192:193], 2.0 op_sel_hi:[1,0]
  v_pk_add_f32 v[198:199], v[196:197], 2.0 op_sel_hi:[1,0]
  v_pk_add_f32 v[202:203], v[200:201], 2.0 op_sel_hi:[1,0]
  v_pk_add_f32 v[206:207], v[204:205], 2.0 op_sel_hi:[1,0]
  v_pk_mul_f32 v[192:193], v[192:193], v[194:195]
  v_pk_mul_f32 v[196:197], v[196:197], v[198:199]
  v_pk_mul_f32 v[200:201], v[200:201], v[202:203]
  v_pk_mul_f32 v[204:205], v[204:205], v[206:207]
  v_pk_add_f32 v[194:195], v[192:193], 2.0 op_sel_hi:[1,0]
  v_pk_add_f32 v[198:199], v[196:197], 2.0 op_sel_hi:[1,0]
  v_pk_add_f32 v[202:203], v[200:201], 2.0 op_sel_hi:[1,0]
  v_pk_add_f32 v[206:207], v[204:205], 2.0 op_sel_hi:[1,0]
  v_rcp_f32 v194, v194
  v_rcp_f32 v195, v195
  v_rcp_f32 v198, v198
  v_rcp_f32 v199, v199
  v_rcp_f32 v202, v202
  v_rcp_f32 v203, v203
  v_rcp_f32 v206, v206
  v_rcp_f32 v207, v207
  v_pk_mul_f32 v[192:193], v[192:193], v[194:195]
  v_pk_mul_f32 v[196:197], v[196:197], v[198:199]
  v_pk_mul_f32 v[200:201], v[200:201], v[202:203]
  v_pk_mul_f32 v[204:205], v[204:205], v[206:207]
  v_pk_mul_f32 v[192:193], v[192:193], v[172:173]
  v_pk_mul_f32 v[196:197], v[196:197], v[174:175]
  v_pk_mul_f32 v[200:201], v[200:201], v[176:177]
  v_pk_mul_f32 v[204:205], v[204:205], v[178:179]
  v_cvt_pk_bf16_f32 v126, v192, v193
  v_cvt_pk_bf16_f32 v127, v196, v197
  v_cvt_pk_bf16_f32 v128, v200, v201
  v_cvt_pk_bf16_f32 v129, v204, v205
  buffer_store_dwordx4 v[126:129], v3, s[40:43], s88 offen sc1
  s_add_u32 s88, s88, 4096
  v_pk_mul_f32 v[192:193], v[180:181], s[84:85]
  v_pk_mul_f32 v[196:197], v[182:183], s[84:85]
  v_pk_mul_f32 v[200:201], v[184:185], s[84:85]
  v_pk_mul_f32 v[204:205], v[186:187], s[84:85]
  v_min_f32 v192, s86, v192
  v_min_f32 v193, s86, v193
  v_min_f32 v196, s86, v196
  v_min_f32 v197, s86, v197
  v_min_f32 v200, s86, v200
  v_min_f32 v201, s86, v201
  v_min_f32 v204, s86, v204
  v_min_f32 v205, s86, v205
  v_exp_f32 v192, v192
  v_exp_f32 v193, v193
  v_exp_f32 v196, v196
  v_exp_f32 v197, v197
  v_exp_f32 v200, v200
  v_exp_f32 v201, v201
  v_exp_f32 v204, v204
  v_exp_f32 v205, v205
  v_pk_add_f32 v[194:195], v[192:193], 2.0 op_sel_hi:[1,0]
  v_pk_add_f32 v[198:199], v[196:197], 2.0 op_sel_hi:[1,0]
  v_pk_add_f32 v[202:203], v[200:201], 2.0 op_sel_hi:[1,0]
  v_pk_add_f32 v[206:207], v[204:205], 2.0 op_sel_hi:[1,0]
  v_pk_mul_f32 v[192:193], v[192:193], v[194:195]
  v_pk_mul_f32 v[196:197], v[196:197], v[198:199]
  v_pk_mul_f32 v[200:201], v[200:201], v[202:203]
  v_pk_mul_f32 v[204:205], v[204:205], v[206:207]
  v_pk_add_f32 v[194:195], v[192:193], 2.0 op_sel_hi:[1,0]
  v_pk_add_f32 v[198:199], v[196:197], 2.0 op_sel_hi:[1,0]
  v_pk_add_f32 v[202:203], v[200:201], 2.0 op_sel_hi:[1,0]
  v_pk_add_f32 v[206:207], v[204:205], 2.0 op_sel_hi:[1,0]
  v_rcp_f32 v194, v194
  v_rcp_f32 v195, v195
  v_rcp_f32 v198, v198
  v_rcp_f32 v199, v199
  v_rcp_f32 v202, v202
  v_rcp_f32 v203, v203
  v_rcp_f32 v206, v206
  v_rcp_f32 v207, v207
  v_pk_mul_f32 v[192:193], v[192:193], v[194:195]
  v_pk_mul_f32 v[196:197], v[196:197], v[198:199]
  v_pk_mul_f32 v[200:201], v[200:201], v[202:203]
  v_pk_mul_f32 v[204:205], v[204:205], v[206:207]
  v_pk_mul_f32 v[192:193], v[192:193], v[180:181]
  v_pk_mul_f32 v[196:197], v[196:197], v[182:183]
  v_pk_mul_f32 v[200:201], v[200:201], v[184:185]
  v_pk_mul_f32 v[204:205], v[204:205], v[186:187]
  v_cvt_pk_bf16_f32 v130, v192, v193
  v_cvt_pk_bf16_f32 v131, v196, v197
  v_cvt_pk_bf16_f32 v132, v200, v201
  v_cvt_pk_bf16_f32 v133, v204, v205
  buffer_store_dwordx4 v[130:133], v3, s[40:43], s88 offen sc1
  s_add_u32 s88, s88, 4096
  v_pk_mul_f32 v[192:193], v[188:189], s[84:85]
  v_pk_mul_f32 v[196:197], v[190:191], s[84:85]
  v_min_f32 v192, s86, v192
  v_min_f32 v193, s86, v193
  v_min_f32 v196, s86, v196
  v_min_f32 v197, s86, v197
  v_exp_f32 v192, v192
  v_exp_f32 v193, v193
  v_exp_f32 v196, v196
  v_exp_f32 v197, v197
  v_pk_add_f32 v[194:195], v[192:193], 2.0 op_sel_hi:[1,0]
  v_pk_add_f32 v[198:199], v[196:197], 2.0 op_sel_hi:[1,0]
  v_pk_mul_f32 v[192:193], v[192:193], v[194:195]
  v_pk_mul_f32 v[196:197], v[196:197], v[198:199]
  v_pk_add_f32 v[194:195], v[192:193], 2.0 op_sel_hi:[1,0]
  v_pk_add_f32 v[198:199], v[196:197], 2.0 op_sel_hi:[1,0]
  v_rcp_f32 v194, v194
  v_rcp_f32 v195, v195
  v_rcp_f32 v198, v198
  v_rcp_f32 v199, v199
  v_pk_mul_f32 v[192:193], v[192:193], v[194:195]
  v_pk_mul_f32 v[196:197], v[196:197], v[198:199]
  v_pk_mul_f32 v[192:193], v[192:193], v[188:189]
  v_pk_mul_f32 v[196:197], v[196:197], v[190:191]
  v_cvt_pk_bf16_f32 v134, v192, v193
  v_cvt_pk_bf16_f32 v135, v196, v197
  buffer_store_dwordx2 v[134:135], v4, s[40:43], s89 offen sc1
  s_lshl_b32 s83, s3, 4
  v_add_u32 v232, s83, v1
  v_cvt_f32_u32 v232, v232
  v_lshlrev_b32 v234, 2, v2
  v_cvt_f32_u32 v234, v234
  v_mul_f32 v233, 0x3c800000, v232
  v_mul_f32 v235, v234, v233
  v_fmamk_f32 v201, v233, 0x3f800000, v235
  v_fmamk_f32 v202, v233, 0x40000000, v235
  v_fmamk_f32 v203, v233, 0x40400000, v235
  v_cos_f32 v204, v235
  v_sin_f32 v208, v235
  v_cos_f32 v205, v201
  v_sin_f32 v209, v201
  v_cos_f32 v206, v202
  v_sin_f32 v210, v202
  v_cos_f32 v207, v203
  v_sin_f32 v211, v203
  v_cvt_pk_bf16_f32 v80, v204, v208
  v_cvt_pk_bf16_f32 v96, -v208, v204
  v_cvt_pk_bf16_f32 v81, v205, v209
  v_cvt_pk_bf16_f32 v97, -v209, v205
  v_cvt_pk_bf16_f32 v82, v206, v210
  v_cvt_pk_bf16_f32 v98, -v210, v206
  v_cvt_pk_bf16_f32 v83, v207, v211
  v_cvt_pk_bf16_f32 v99, -v211, v207
  v_fmamk_f32 v200, v233, 0x41800000, v235
  v_fmamk_f32 v201, v233, 0x41880000, v235
  v_fmamk_f32 v202, v233, 0x41900000, v235
  v_fmamk_f32 v203, v233, 0x41980000, v235
  v_cos_f32 v204, v200
  v_sin_f32 v208, v200
  v_cos_f32 v205, v201
  v_sin_f32 v209, v201
  v_cos_f32 v206, v202
  v_sin_f32 v210, v202
  v_cos_f32 v207, v203
  v_sin_f32 v211, v203
  v_cvt_pk_bf16_f32 v84, v204, v208
  v_cvt_pk_bf16_f32 v100, -v208, v204
  v_cvt_pk_bf16_f32 v85, v205, v209
  v_cvt_pk_bf16_f32 v101, -v209, v205
  v_cvt_pk_bf16_f32 v86, v206, v210
  v_cvt_pk_bf16_f32 v102, -v210, v206
  v_cvt_pk_bf16_f32 v87, v207, v211
  v_cvt_pk_bf16_f32 v103, -v211, v207
  v_fmamk_f32 v200, v233, 0x42000000, v235
  v_fmamk_f32 v201, v233, 0x42040000, v235
  v_fmamk_f32 v202, v233, 0x42080000, v235
  v_fmamk_f32 v203, v233, 0x420c0000, v235
  v_cos_f32 v204, v200
  v_sin_f32 v208, v200
  v_cos_f32 v205, v201
  v_sin_f32 v209, v201
  v_cos_f32 v206, v202
  v_sin_f32 v210, v202
  v_cos_f32 v207, v203
  v_sin_f32 v211, v203
  v_cvt_pk_bf16_f32 v88, v204, v208
  v_cvt_pk_bf16_f32 v104, -v208, v204
  v_cvt_pk_bf16_f32 v89, v205, v209
  v_cvt_pk_bf16_f32 v105, -v209, v205
  v_cvt_pk_bf16_f32 v90, v206, v210
  v_cvt_pk_bf16_f32 v106, -v210, v206
  v_cvt_pk_bf16_f32 v91, v207, v211
  v_cvt_pk_bf16_f32 v107, -v211, v207
  v_fmamk_f32 v200, v233, 0x42400000, v235
  v_fmamk_f32 v201, v233, 0x42440000, v235
  v_fmamk_f32 v202, v233, 0x42480000, v235
  v_fmamk_f32 v203, v233, 0x424c0000, v235
  v_cos_f32 v204, v200
  v_sin_f32 v208, v200
  v_cos_f32 v205, v201
  v_sin_f32 v209, v201
  v_cos_f32 v206, v202
  v_sin_f32 v210, v202
  v_cos_f32 v207, v203
  v_sin_f32 v211, v203
  v_cvt_pk_bf16_f32 v92, v204, v208
  v_cvt_pk_bf16_f32 v108, -v208, v204
  v_cvt_pk_bf16_f32 v93, v205, v209
  v_cvt_pk_bf16_f32 v109, -v209, v205
  v_cvt_pk_bf16_f32 v94, v206, v210
  v_cvt_pk_bf16_f32 v110, -v210, v206
  v_cvt_pk_bf16_f32 v95, v207, v211
  v_cvt_pk_bf16_f32 v111, -v211, v207
  v_mul_f32 v233, 0x3a000000, v232
  v_mul_f32 v235, v234, v233
  v_fmamk_f32 v201, v233, 0x3f800000, v235
  v_fmamk_f32 v202, v233, 0x40000000, v235
  v_fmamk_f32 v203, v233, 0x40400000, v235
  v_cos_f32 v144, v235
  v_sin_f32_e64 v152, -v235
  v_cos_f32 v145, v201
  v_sin_f32_e64 v153, -v201
  v_cos_f32 v146, v202
  v_sin_f32_e64 v154, -v202
  v_cos_f32 v147, v203
  v_sin_f32_e64 v155, -v203
  v_fmamk_f32 v200, v233, 0x41800000, v235
  v_fmamk_f32 v201, v233, 0x41880000, v235
  v_fmamk_f32 v202, v233, 0x41900000, v235
  v_fmamk_f32 v203, v233, 0x41980000, v235
  v_cos_f32 v148, v200
  v_sin_f32_e64 v156, -v200
  v_cos_f32 v149, v201
  v_sin_f32_e64 v157, -v201
  v_cos_f32 v150, v202
  v_sin_f32_e64 v158, -v202
  v_cos_f32 v151, v203
  v_sin_f32_e64 v159, -v203
  v_cvt_f32_u32 v239, v1
  v_add_f32 v233, 0x0, v239
  v_mul_f32 v233, 0x3d000000, v233
  v_mul_f32 v235, v234, v233
  v_fmamk_f32 v201, v233, 0x3f800000, v235
  v_fmamk_f32 v202, v233, 0x40000000, v235
  v_fmamk_f32 v203, v233, 0x40400000, v235
  v_cos_f32 v204, v235
  v_sin_f32 v208, v235
  v_cos_f32 v205, v201
  v_sin_f32 v209, v201
  v_cos_f32 v206, v202
  v_sin_f32 v210, v202
  v_cos_f32 v207, v203
  v_sin_f32 v211, v203
  v_cvt_pk_bf16_f32 v112, v204, v208
  v_cvt_pk_bf16_f32 v128, -v208, v204
  v_cvt_pk_bf16_f32 v113, v205, v209
  v_cvt_pk_bf16_f32 v129, -v209, v205
  v_cvt_pk_bf16_f32 v114, v206, v210
  v_cvt_pk_bf16_f32 v130, -v210, v206
  v_cvt_pk_bf16_f32 v115, v207, v211
  v_cvt_pk_bf16_f32 v131, -v211, v207
  v_fmamk_f32 v200, v233, 0x41800000, v235
  v_fmamk_f32 v201, v233, 0x41880000, v235
  v_fmamk_f32 v202, v233, 0x41900000, v235
  v_fmamk_f32 v203, v233, 0x41980000, v235
  v_cos_f32 v204, v200
  v_sin_f32 v208, v200
  v_cos_f32 v205, v201
  v_sin_f32 v209, v201
  v_cos_f32 v206, v202
  v_sin_f32 v210, v202
  v_cos_f32 v207, v203
  v_sin_f32 v211, v203
  v_cvt_pk_bf16_f32 v116, v204, v208
  v_cvt_pk_bf16_f32 v132, -v208, v204
  v_cvt_pk_bf16_f32 v117, v205, v209
  v_cvt_pk_bf16_f32 v133, -v209, v205
  v_cvt_pk_bf16_f32 v118, v206, v210
  v_cvt_pk_bf16_f32 v134, -v210, v206
  v_cvt_pk_bf16_f32 v119, v207, v211
  v_cvt_pk_bf16_f32 v135, -v211, v207
  v_add_f32 v233, 0x41800000, v239
  v_mul_f32 v233, 0x3d000000, v233
  v_mul_f32 v235, v234, v233
  v_fmamk_f32 v201, v233, 0x3f800000, v235
  v_fmamk_f32 v202, v233, 0x40000000, v235
  v_fmamk_f32 v203, v233, 0x40400000, v235
  v_cos_f32 v204, v235
  v_sin_f32 v208, v235
  v_cos_f32 v205, v201
  v_sin_f32 v209, v201
  v_cos_f32 v206, v202
  v_sin_f32 v210, v202
  v_cos_f32 v207, v203
  v_sin_f32 v211, v203
  v_cvt_pk_bf16_f32 v120, v204, v208
  v_cvt_pk_bf16_f32 v136, -v208, v204
  v_cvt_pk_bf16_f32 v121, v205, v209
  v_cvt_pk_bf16_f32 v137, -v209, v205
  v_cvt_pk_bf16_f32 v122, v206, v210
  v_cvt_pk_bf16_f32 v138, -v210, v206
  v_cvt_pk_bf16_f32 v123, v207, v211
  v_cvt_pk_bf16_f32 v139, -v211, v207
  v_fmamk_f32 v200, v233, 0x41800000, v235
  v_fmamk_f32 v201, v233, 0x41880000, v235
  v_fmamk_f32 v202, v233, 0x41900000, v235
  v_fmamk_f32 v203, v233, 0x41980000, v235
  v_cos_f32 v204, v200
  v_sin_f32 v208, v200
  v_cos_f32 v205, v201
  v_sin_f32 v209, v201
  v_cos_f32 v206, v202
  v_sin_f32 v210, v202
  v_cos_f32 v207, v203
  v_sin_f32 v211, v203
  v_cvt_pk_bf16_f32 v124, v204, v208
  v_cvt_pk_bf16_f32 v140, -v208, v204
  v_cvt_pk_bf16_f32 v125, v205, v209
  v_cvt_pk_bf16_f32 v141, -v209, v205
  v_cvt_pk_bf16_f32 v126, v206, v210
  v_cvt_pk_bf16_f32 v142, -v210, v206
  v_cvt_pk_bf16_f32 v127, v207, v211
  v_cvt_pk_bf16_f32 v143, -v211, v207
  v_cvt_f32_u32 v232, s83
  v_add_f32 v234, v232, v234
  v_add_f32 v233, 0x0, v239
  v_mul_f32 v233, 0x3a000000, v233
  v_mul_f32 v235, v234, v233
  v_fmamk_f32 v201, v233, 0x3f800000, v235
  v_fmamk_f32 v202, v233, 0x40000000, v235
  v_fmamk_f32 v203, v233, 0x40400000, v235
  v_cos_f32 v160, v235
  v_sin_f32_e64 v168, -v235
  v_cos_f32 v161, v201
  v_sin_f32_e64 v169, -v201
  v_cos_f32 v162, v202
  v_sin_f32_e64 v170, -v202
  v_cos_f32 v163, v203
  v_sin_f32_e64 v171, -v203
  v_add_f32 v233, 0x41800000, v239
  v_mul_f32 v233, 0x3a000000, v233
  v_mul_f32 v235, v234, v233
  v_fmamk_f32 v201, v233, 0x3f800000, v235
  v_fmamk_f32 v202, v233, 0x40000000, v235
  v_fmamk_f32 v203, v233, 0x40400000, v235
  v_cos_f32 v164, v235
  v_sin_f32_e64 v172, -v235
  v_cos_f32 v165, v201
  v_sin_f32_e64 v173, -v201
  v_cos_f32 v166, v202
  v_sin_f32_e64 v174, -v202
  v_cos_f32 v167, v203
  v_sin_f32_e64 v175, -v203
  s_mov_b32 s93, 32
  s_cmp_lg_u32 s3, 0
  s_cbranch_scc1 L_pw2869
  v_mul_u32_u24 v251, 0, v0
  s_mov_b64 exec, 0x1
  s_mov_b32 s94, 0
L_poll2871:
  buffer_load_dword v250, v251, s[44:47], s93 offen sc1
  s_add_u32 s94, s94, 1
  s_waitcnt vmcnt(0)
  v_cmp_gt_u32 vcc, 1, v250
  s_nop 4
  s_cbranch_vccz L_poll2871_done
  s_cmp_gt_u32 s94, 50000
  s_cbranch_scc1 L_poll2871_done
  s_sleep 16
  s_branch L_poll2871
L_poll2871_done:
  s_mov_b64 exec, -1
L_pw2869:
  s_waitcnt vmcnt(0)
  s_barrier
  s_lshl_b32 s56, s4, 5
  s_add_u32 s56, s56, s5
  s_lshl_b32 s60, s56, 13
  s_lshl_b32 s61, s3, 11
  s_add_u32 s60, s60, s61
  s_add_u32 s62, s60, 2097152
  s_add_u32 s63, s61, 4202496
  s_add_u32 s64, s61, 4194304
  buffer_load_dwordx4 v[48:51], v3, s[40:43], s63 offen offset:0 sc1
  buffer_load_dwordx4 v[52:55], v3, s[40:43], s63 offen offset:1024 sc1
  s_cmp_eq_u32 s56, 0
  s_cselect_b32 s65, 0, 1073741824
  v_add_u32 v66, s65, v3
  buffer_load_dwordx4 v[56:59], v66, s[40:43], s64 offen offset:0 sc1
  buffer_load_dwordx4 v[60:63], v66, s[40:43], s64 offen offset:1024 sc1
  v_lshrrev_b32 v68, 1, v2
  v_lshlrev_b32 v68, 5, v68
  v_lshl_add_u32 v68, v1, 1, v68
  v_and_b32 v69, 1, v2
  v_add_u32 v68, v68, v69
  v_lshlrev_b32 v68, 4, v68
  v_add_u32 v68, 131072, v68
  ds_read_b128 v[8:11], v68 offset:0
  ds_read_b128 v[24:27], v68 offset:1024
  ds_read_b128 v[12:15], v68 offset:2048
  ds_read_b128 v[28:31], v68 offset:3072
  ds_read_b128 v[16:19], v68 offset:4096
  ds_read_b128 v[32:35], v68 offset:5120
  ds_read_b128 v[20:23], v68 offset:6144
  ds_read_b128 v[36:39], v68 offset:7168
  s_lshl_b32 s65, s3, 11
  s_add_u32 s65, s65, 155648
  v_add_u32 v70, s65, v3
  ds_read_b128 v[40:43], v70 offset:0
  ds_read_b128 v[44:47], v70 offset:1024
  s_waitcnt lgkmcnt(8)
  v_mfma_f32_16x16x32_bf16 v[176:179], v[8:11], v[80:83], 0
  v_mfma_f32_16x16x32_bf16 v[184:187], v[8:11], v[96:99], 0
  v_mfma_f32_16x16x32_bf16 v[180:183], v[24:27], v[80:83], 0
  v_mfma_f32_16x16x32_bf16 v[188:191], v[24:27], v[96:99], 0
  s_waitcnt lgkmcnt(6)
  v_mfma_f32_16x16x32_bf16 v[176:179], v[12:15], v[84:87], v[176:179]
  v_mfma_f32_16x16x32_bf16 v[184:187], v[12:15], v[100:103], v[184:187]
  v_mfma_f32_16x16x32_bf16 v[180:183], v[28:31], v[84:87], v[180:183]
  v_mfma_f32_16x16x32_bf16 v[188:191], v[28:31], v[100:103], v[188:191]
  s_waitcnt lgkmcnt(4)
  v_mfma_f32_16x16x32_bf16 v[176:179], v[16:19], v[88:91], v[176:179]
  v_mfma_f32_16x16x32_bf16 v[184:187], v[16:19], v[104:107], v[184:187]
  v_mfma_f32_16x16x32_bf16 v[180:183], v[32:35], v[88:91], v[180:183]
  v_mfma_f32_16x16x32_bf16 v[188:191], v[32:35], v[104:107], v[188:191]
  s_waitcnt lgkmcnt(2)
  v_mfma_f32_16x16x32_bf16 v[176:179], v[20:23], v[92:95], v[176:179]
  v_mfma_f32_16x16x32_bf16 v[184:187], v[20:23], v[108:111], v[184:187]
  v_mfma_f32_16x16x32_bf16 v[180:183], v[36:39], v[92:95], v[180:183]
  v_mfma_f32_16x16x32_bf16 v[188:191], v[36:39], v[108:111], v[188:191]
  s_waitcnt lgkmcnt(0)
  v_lshlrev_b32 v216, 16, v40
  v_and_b32 v224, 0xffff0000, v40
  v_lshlrev_b32 v217, 16, v41
  v_and_b32 v225, 0xffff0000, v41
  v_lshlrev_b32 v218, 16, v42
  v_and_b32 v226, 0xffff0000, v42
  v_lshlrev_b32 v219, 16, v43
  v_and_b32 v227, 0xffff0000, v43
  v_lshlrev_b32 v220, 16, v44
  v_and_b32 v228, 0xffff0000, v44
  v_lshlrev_b32 v221, 16, v45
  v_and_b32 v229, 0xffff0000, v45
  v_lshlrev_b32 v222, 16, v46
  v_and_b32 v230, 0xffff0000, v46
  v_lshlrev_b32 v223, 16, v47
  v_and_b32 v231, 0xffff0000, v47
  v_pk_mul_f32 v[200:201], v[184:185], v[152:153]
  v_pk_mul_f32 v[204:205], v[186:187], v[154:155]
  v_pk_mul_f32 v[202:203], v[184:185], v[144:145]
  v_pk_mul_f32 v[206:207], v[186:187], v[146:147]
  v_pk_fma_f32 v[200:201], v[176:177], v[144:145], v[200:201] neg_lo:[0,0,1] neg_hi:[0,0,1]
  v_pk_fma_f32 v[204:205], v[178:179], v[146:147], v[204:205] neg_lo:[0,0,1] neg_hi:[0,0,1]
  v_pk_fma_f32 v[202:203], v[176:177], v[152:153], v[202:203]
  v_pk_fma_f32 v[206:207], v[178:179], v[154:155], v[206:207]
  v_cvt_pk_bf16_f32 v192, v200, v202
  v_cvt_pk_bf16_f32 v193, v201, v203
  v_cvt_pk_bf16_f32 v194, v204, v206
  v_cvt_pk_bf16_f32 v195, v205, v207
  v_pk_mul_f32 v[200:201], v[188:189], v[156:157]
  v_pk_mul_f32 v[204:205], v[190:191], v[158:159]
  v_pk_mul_f32 v[202:203], v[188:189], v[148:149]
  v_pk_mul_f32 v[206:207], v[190:191], v[150:151]
  v_pk_fma_f32 v[200:201], v[180:181], v[148:149], v[200:201] neg_lo:[0,0,1] neg_hi:[0,0,1]
  v_pk_fma_f32 v[204:205], v[182:183], v[150:151], v[204:205] neg_lo:[0,0,1] neg_hi:[0,0,1]
  v_pk_fma_f32 v[202:203], v[180:181], v[156:157], v[202:203]
  v_pk_fma_f32 v[206:207], v[182:183], v[158:159], v[206:207]
  v_cvt_pk_bf16_f32 v196, v200, v202
  v_cvt_pk_bf16_f32 v197, v201, v203
  v_cvt_pk_bf16_f32 v198, v204, v206
  v_cvt_pk_bf16_f32 v199, v205, v207
  v_mfma_f32_16x16x32_bf16 v[176:179], v[112:115], v[192:195], 0
  v_mfma_f32_16x16x32_bf16 v[184:187], v[128:131], v[192:195], 0
  v_mfma_f32_16x16x32_bf16 v[180:183], v[120:123], v[192:195], 0
  v_mfma_f32_16x16x32_bf16 v[188:191], v[136:139], v[192:195], 0
  v_mfma_f32_16x16x32_bf16 v[176:179], v[116:119], v[196:199], v[176:179]
  v_mfma_f32_16x16x32_bf16 v[184:187], v[132:135], v[196:199], v[184:187]
  v_mfma_f32_16x16x32_bf16 v[180:183], v[124:127], v[196:199], v[180:183]
  v_mfma_f32_16x16x32_bf16 v[188:191], v[140:143], v[196:199], v[188:191]
  s_lshl_b32 s65, s3, 11
  s_add_u32 s65, s65, 139264
  v_add_u32 v68, s65, v3
  v_add_u32 v69, 139264, v3
  s_cmp_lg_u32 s56, 0
  s_cbranch_scc0 L_p2_special
  v_pk_mul_f32 v[200:201], v[184:185], v[224:225]
  v_pk_mul_f32 v[204:205], v[186:187], v[226:227]
  v_pk_mul_f32 v[202:203], v[184:185], v[216:217]
  v_pk_mul_f32 v[206:207], v[186:187], v[218:219]
  v_pk_fma_f32 v[200:201], v[176:177], v[216:217], v[200:201] neg_lo:[0,0,1] neg_hi:[0,0,1]
  v_pk_fma_f32 v[204:205], v[178:179], v[218:219], v[204:205] neg_lo:[0,0,1] neg_hi:[0,0,1]
  v_pk_fma_f32 v[202:203], v[176:177], v[224:225], v[202:203]
  v_pk_fma_f32 v[206:207], v[178:179], v[226:227], v[206:207]
  v_cvt_pk_bf16_f32 v192, v200, -v202
  v_cvt_pk_bf16_f32 v193, v201, -v203
  v_cvt_pk_bf16_f32 v194, v204, -v206
  v_cvt_pk_bf16_f32 v195, v205, -v207
  v_pk_mul_f32 v[200:201], v[188:189], v[228:229]
  v_pk_mul_f32 v[204:205], v[190:191], v[230:231]
  v_pk_mul_f32 v[202:203], v[188:189], v[220:221]
  v_pk_mul_f32 v[206:207], v[190:191], v[222:223]
  v_pk_fma_f32 v[200:201], v[180:181], v[220:221], v[200:201] neg_lo:[0,0,1] neg_hi:[0,0,1]
  v_pk_fma_f32 v[204:205], v[182:183], v[222:223], v[204:205] neg_lo:[0,0,1] neg_hi:[0,0,1]
  v_pk_fma_f32 v[202:203], v[180:181], v[228:229], v[202:203]
  v_pk_fma_f32 v[206:207], v[182:183], v[230:231], v[206:207]
  v_cvt_pk_bf16_f32 v196, v200, -v202
  v_cvt_pk_bf16_f32 v197, v201, -v203
  v_cvt_pk_bf16_f32 v198, v204, -v206
  v_cvt_pk_bf16_f32 v199, v205, -v207
L_p2_join:
  v_mfma_f32_16x16x32_bf16 v[176:179], v[192:195], v[112:115], 0
  v_mfma_f32_16x16x32_bf16 v[184:187], v[192:195], v[128:131], 0
  v_mfma_f32_16x16x32_bf16 v[180:183], v[192:195], v[120:123], 0
  v_mfma_f32_16x16x32_bf16 v[188:191], v[192:195], v[136:139], 0
  v_mfma_f32_16x16x32_bf16 v[176:179], v[196:199], v[116:119], v[176:179]
  v_mfma_f32_16x16x32_bf16 v[184:187], v[196:199], v[132:135], v[184:187]
  v_mfma_f32_16x16x32_bf16 v[180:183], v[196:199], v[124:127], v[180:183]
  v_mfma_f32_16x16x32_bf16 v[188:191], v[196:199], v[140:143], v[188:191]
  s_nop 5
  v_pk_mul_f32 v[200:201], v[184:185], v[168:169]
  v_pk_mul_f32 v[204:205], v[186:187], v[170:171]
  v_pk_mul_f32 v[202:203], v[184:185], v[160:161]
  v_pk_mul_f32 v[206:207], v[186:187], v[162:163]
  v_pk_fma_f32 v[200:201], v[176:177], v[160:161], v[200:201] neg_lo:[0,0,1] neg_hi:[0,0,1]
  v_pk_fma_f32 v[204:205], v[178:179], v[162:163], v[204:205] neg_lo:[0,0,1] neg_hi:[0,0,1]
  v_pk_fma_f32 v[202:203], v[176:177], v[168:169], v[202:203]
  v_pk_fma_f32 v[206:207], v[178:179], v[170:171], v[206:207]
  v_cvt_pk_bf16_f32 v192, v200, v202
  v_cvt_pk_bf16_f32 v193, v201, v203
  v_cvt_pk_bf16_f32 v194, v204, v206
  v_cvt_pk_bf16_f32 v195, v205, v207
  ds_write_b128 v68, v[192:195] offset:0
  v_pk_mul_f32 v[200:201], v[188:189], v[172:173]
  v_pk_mul_f32 v[204:205], v[190:191], v[174:175]
  v_pk_mul_f32 v[202:203], v[188:189], v[164:165]
  v_pk_mul_f32 v[206:207], v[190:191], v[166:167]
  v_pk_fma_f32 v[200:201], v[180:181], v[164:165], v[200:201] neg_lo:[0,0,1] neg_hi:[0,0,1]
  v_pk_fma_f32 v[204:205], v[182:183], v[166:167], v[204:205] neg_lo:[0,0,1] neg_hi:[0,0,1]
  v_pk_fma_f32 v[202:203], v[180:181], v[172:173], v[202:203]
  v_pk_fma_f32 v[206:207], v[182:183], v[174:175], v[206:207]
  v_cvt_pk_bf16_f32 v196, v200, v202
  v_cvt_pk_bf16_f32 v197, v201, v203
  v_cvt_pk_bf16_f32 v198, v204, v206
  v_cvt_pk_bf16_f32 v199, v205, v207
  ds_write_b128 v68, v[196:199] offset:1024
  s_waitcnt lgkmcnt(0)
  s_barrier
  ds_read_b128 v[8:11], v69 offset:0
  ds_read_b128 v[12:15], v69 offset:1024
  ds_read_b128 v[16:19], v69 offset:2048
  ds_read_b128 v[20:23], v69 offset:3072
  ds_read_b128 v[24:27], v69 offset:4096
  ds_read_b128 v[28:31], v69 offset:5120
  ds_read_b128 v[32:35], v69 offset:6144
  ds_read_b128 v[36:39], v69 offset:7168
  s_waitcnt lgkmcnt(6)
  v_mfma_f32_16x16x32_bf16 v[176:179], v[80:83], v[8:11], 0
  v_mfma_f32_16x16x32_bf16 v[184:187], v[96:99], v[8:11], 0
  v_mfma_f32_16x16x32_bf16 v[180:183], v[80:83], v[12:15], 0
  v_mfma_f32_16x16x32_bf16 v[188:191], v[96:99], v[12:15], 0
  s_waitcnt lgkmcnt(4)
  v_mfma_f32_16x16x32_bf16 v[176:179], v[84:87], v[16:19], v[176:179]
  v_mfma_f32_16x16x32_bf16 v[184:187], v[100:103], v[16:19], v[184:187]
  v_mfma_f32_16x16x32_bf16 v[180:183], v[84:87], v[20:23], v[180:183]
  v_mfma_f32_16x16x32_bf16 v[188:191], v[100:103], v[20:23], v[188:191]
  s_waitcnt lgkmcnt(2)
  v_mfma_f32_16x16x32_bf16 v[176:179], v[88:91], v[24:27], v[176:179]
  v_mfma_f32_16x16x32_bf16 v[184:187], v[104:107], v[24:27], v[184:187]
  v_mfma_f32_16x16x32_bf16 v[180:183], v[88:91], v[28:31], v[180:183]
  v_mfma_f32_16x16x32_bf16 v[188:191], v[104:107], v[28:31], v[188:191]
  s_waitcnt lgkmcnt(0)
  v_mfma_f32_16x16x32_bf16 v[176:179], v[92:95], v[32:35], v[176:179]
  v_mfma_f32_16x16x32_bf16 v[184:187], v[108:111], v[32:35], v[184:187]
  v_mfma_f32_16x16x32_bf16 v[180:183], v[92:95], v[36:39], v[180:183]
  v_mfma_f32_16x16x32_bf16 v[188:191], v[108:111], v[36:39], v[188:191]
  s_waitcnt vmcnt(0)
  v_mul_f32 v48, 0x36000000, v48
  v_mul_f32 v49, 0x36000000, v49
  v_mul_f32 v50, 0x36000000, v50
  v_mul_f32 v51, 0x36000000, v51
  v_mul_f32 v52, 0x36000000, v52
  v_mul_f32 v53, 0x36000000, v53
  v_mul_f32 v54, 0x36000000, v54
  v_mul_f32 v55, 0x36000000, v55
  s_add_u32 s62, s60, 6291456
  v_pk_mul_f32 v[176:177], v[176:177], v[48:49]
  v_pk_mul_f32 v[184:185], v[184:185], v[48:49]
  v_pk_mul_f32 v[178:179], v[178:179], v[50:51]
  v_pk_mul_f32 v[186:187], v[186:187], v[50:51]
  v_cvt_pk_bf16_f32 v192, v176, v184
  v_cvt_pk_bf16_f32 v193, v177, v185
  v_cvt_pk_bf16_f32 v194, v178, v186
  v_cvt_pk_bf16_f32 v195, v179, v187
  v_pk_mul_f32 v[180:181], v[180:181], v[52:53]
  v_pk_mul_f32 v[188:189], v[188:189], v[52:53]
  v_pk_mul_f32 v[182:183], v[182:183], v[54:55]
  v_pk_mul_f32 v[190:191], v[190:191], v[54:55]
  v_cvt_pk_bf16_f32 v196, v180, v188
  v_cvt_pk_bf16_f32 v197, v181, v189
  v_cvt_pk_bf16_f32 v198, v182, v190
  v_cvt_pk_bf16_f32 v199, v183, v191
  s_lshl_b32 s67, s4, 2
  s_lshr_b32 s68, s5, 3
  s_add_u32 s67, s67, s68
  s_and_b32 s68, s5, 7
  s_mul_i32 s69, s67, 229376
  s_mul_i32 s70, s3, 57344
  s_add_u32 s69, s69, s70
  s_add_u32 s69, s69, 8388608
  s_mul_i32 s70, s3, 458752
  s_lshl_b32 s71, s68, 7
  s_add_u32 s70, s70, s71
  s_lshl_b32 s71, s3, 15
  s_lshr_b32 s72, s67, 1
  s_and_b32 s73, s67, 1
  s_lshr_b32 s74, s72, 2
  s_lshl_b32 s74, s74, 11
  s_lshl_b32 s75, s73, 10
  s_add_u32 s74, s74, s75
  s_and_b32 s75, s72, 3
  s_lshl_b32 s75, s75, 8
  s_add_u32 s74, s74, s75
  v_lshrrev_b32 v5, 3, v0
  v_lshlrev_b32 v244, 10, v5
  v_lshrrev_b32 v5, 1, v5
  v_and_b32 v5, 3, v5
  v_bfe_u32 v6, v0, 1, 2
  v_xor_b32 v5, v5, v6
  v_lshlrev_b32 v5, 1, v5
  v_and_b32 v6, 1, v0
  v_add_u32 v5, v5, v6
  v_lshl_add_u32 v244, v5, 4, v244
  v_lshrrev_b32 v5, 2, v1
  v_lshl_add_u32 v6, v2, 2, v5
  v_lshlrev_b32 v240, 7, v6
  v_lshrrev_b32 v6, 1, v6
  v_and_b32 v6, 3, v6
  v_and_b32 v5, 3, v0
  v_lshl_add_u32 v240, v5, 3, v240
  v_add_u32 v240, s71, v240
  v_xor_b32 v5, 3, v6
  v_lshl_add_u32 v243, v5, 5, v240
  v_xor_b32 v5, 2, v6
  v_lshl_add_u32 v242, v5, 5, v240
  v_xor_b32 v5, 1, v6
  v_lshl_add_u32 v241, v5, 5, v240
  v_xor_b32 v5, 0, v6
  v_lshl_add_u32 v240, v5, 5, v240
  s_barrier
  v_lshlrev_b32 v4, 3, v0
  buffer_load_dwordx4 v[8:11], v3, s[40:43], s69 offen offset:0 sc1
  buffer_load_dwordx4 v[12:15], v3, s[40:43], s69 offen offset:1024 sc1
  buffer_load_dwordx4 v[16:19], v3, s[40:43], s69 offen offset:2048 sc1
  buffer_load_dwordx4 v[20:23], v3, s[40:43], s69 offen offset:3072 sc1
  s_add_u32 s69, s69, 4096
  buffer_load_dwordx4 v[24:27], v3, s[40:43], s69 offen offset:0 sc1
  buffer_load_dwordx4 v[28:31], v3, s[40:43], s69 offen offset:1024 sc1
  buffer_load_dwordx4 v[32:35], v3, s[40:43], s69 offen offset:2048 sc1
  buffer_load_dwordx4 v[36:39], v3, s[40:43], s69 offen offset:3072 sc1
  s_add_u32 s69, s69, 4096
  buffer_load_dwordx4 v[40:43], v3, s[40:43], s69 offen offset:0 sc1
  buffer_load_dwordx4 v[44:47], v3, s[40:43], s69 offen offset:1024 sc1
  buffer_load_dwordx4 v[48:51], v3, s[40:43], s69 offen offset:2048 sc1
  buffer_load_dwordx4 v[52:55], v3, s[40:43], s69 offen offset:3072 sc1
  s_add_u32 s69, s69, 4096
  buffer_load_dwordx2 v[56:57], v4, s[40:43], s69 offen offset:0 sc1
  buffer_load_dwordx2 v[58:59], v4, s[40:43], s69 offen offset:512 sc1
  buffer_load_dwordx2 v[60:61], v4, s[40:43], s69 offen offset:1024 sc1
  buffer_load_dwordx2 v[62:63], v4, s[40:43], s69 offen offset:1536 sc1
  buffer_load_dwordx2 v[64:65], v4, s[40:43], s69 offen offset:2048 sc1
  buffer_load_dwordx2 v[66:67], v4, s[40:43], s69 offen offset:2560 sc1
  buffer_load_dwordx2 v[68:69], v4, s[40:43], s69 offen offset:3072 sc1
  buffer_load_dwordx2 v[70:71], v4, s[40:43], s69 offen offset:3584 sc1
  s_add_u32 s69, s69, 4096
  buffer_load_dwordx4 v[160:163], v3, s[40:43], s69 offen offset:0 sc1
  buffer_load_dwordx4 v[164:167], v3, s[40:43], s69 offen offset:1024 sc1
  buffer_load_dwordx4 v[168:171], v3, s[40:43], s69 offen offset:2048 sc1
  buffer_load_dwordx4 v[172:175], v3, s[40:43], s69 offen offset:3072 sc1
  s_add_u32 s69, s69, 4096
  buffer_load_dwordx4 v[176:179], v3, s[40:43], s69 offen offset:0 sc1
  buffer_load_dwordx4 v[180:183], v3, s[40:43], s69 offen offset:1024 sc1
  buffer_load_dwordx4 v[184:187], v3, s[40:43], s69 offen offset:2048 sc1
  buffer_load_dwordx4 v[188:191], v3, s[40:43], s69 offen offset:3072 sc1
  s_add_u32 s69, s69, 4096
  buffer_store_dwordx4 v[192:195], v3, s[40:43], s62 offen offset:0 sc1
  buffer_store_dwordx4 v[196:199], v3, s[40:43], s62 offen offset:1024 sc1
  v_lshlrev_b32 v5, 4, v1
  v_lshlrev_b32 v6, 15, v2
  v_add_u32 v6, v6, v5
  v_add_u32 v7, s71, v3
  s_lshl_b32 s78, s3, 19
  s_add_u32 s78, s78, s74
  s_add_u32 s78, s78, 6291456
  ds_read_b64_tr_b16 v[144:145], v240 offset:0
  ds_read_b64_tr_b16 v[146:147], v240 offset:2048
  ds_read_b64_tr_b16 v[148:149], v241 offset:0
  ds_read_b64_tr_b16 v[150:151], v241 offset:2048
  ds_read_b64_tr_b16 v[152:153], v242 offset:0
  ds_read_b64_tr_b16 v[154:155], v242 offset:2048
  ds_read_b64_tr_b16 v[156:157], v243 offset:0
  ds_read_b64_tr_b16 v[158:159], v243 offset:2048
  s_waitcnt vmcnt(26)
  s_waitcnt lgkmcnt(6)
  v_mfma_f32_16x16x32_bf16 v[80:83], v[144:147], v[8:11], 0
  v_mfma_f32_16x16x32_bf16 v[96:99], v[144:147], v[12:15], 0
  v_mfma_f32_16x16x32_bf16 v[112:115], v[144:147], v[16:19], 0
  buffer_load_dwordx4 v[192:195], v3, s[40:43], s69 offen offset:0 sc1
  v_mfma_f32_16x16x32_bf16 v[128:131], v[144:147], v[20:23], 0
  buffer_load_dwordx4 v[196:199], v3, s[40:43], s69 offen offset:1024 sc1
  s_waitcnt lgkmcnt(4)
  v_mfma_f32_16x16x32_bf16 v[84:87], v[148:151], v[8:11], 0
  ds_read_b64_tr_b16 v[144:145], v240 offset:4096
  v_mfma_f32_16x16x32_bf16 v[100:103], v[148:151], v[12:15], 0
  ds_read_b64_tr_b16 v[146:147], v240 offset:6144
  v_mfma_f32_16x16x32_bf16 v[116:119], v[148:151], v[16:19], 0
  buffer_load_dwordx4 v[200:203], v3, s[40:43], s69 offen offset:2048 sc1
  v_mfma_f32_16x16x32_bf16 v[132:135], v[148:151], v[20:23], 0
  buffer_load_dwordx4 v[204:207], v3, s[40:43], s69 offen offset:3072 sc1
  s_add_u32 s69, s69, 4096
  s_waitcnt lgkmcnt(4)
  v_mfma_f32_16x16x32_bf16 v[88:91], v[152:155], v[8:11], 0
  ds_read_b64_tr_b16 v[148:149], v241 offset:4096
  v_mfma_f32_16x16x32_bf16 v[104:107], v[152:155], v[12:15], 0
  ds_read_b64_tr_b16 v[150:151], v241 offset:6144
  v_mfma_f32_16x16x32_bf16 v[120:123], v[152:155], v[16:19], 0
  buffer_load_dwordx4 v[208:211], v3, s[40:43], s69 offen offset:0 sc1
  v_mfma_f32_16x16x32_bf16 v[136:139], v[152:155], v[20:23], 0
  buffer_load_dwordx4 v[212:215], v3, s[40:43], s69 offen offset:1024 sc1
  s_waitcnt lgkmcnt(4)
  v_mfma_f32_16x16x32_bf16 v[92:95], v[156:159], v[8:11], 0
  ds_read_b64_tr_b16 v[152:153], v242 offset:4096
  v_mfma_f32_16x16x32_bf16 v[108:111], v[156:159], v[12:15], 0
  ds_read_b64_tr_b16 v[154:155], v242 offset:6144
  v_mfma_f32_16x16x32_bf16 v[124:127], v[156:159], v[16:19], 0
  buffer_load_dwordx4 v[216:219], v3, s[40:43], s69 offen offset:2048 sc1
  v_mfma_f32_16x16x32_bf16 v[140:143], v[156:159], v[20:23], 0
  buffer_load_dwordx4 v[220:223], v3, s[40:43], s69 offen offset:3072 sc1
  s_add_u32 s69, s69, 4096
  s_waitcnt vmcnt(30)
  s_waitcnt lgkmcnt(4)
  v_mfma_f32_16x16x32_bf16 v[80:83], v[144:147], v[24:27], v[80:83]
  ds_read_b64_tr_b16 v[156:157], v243 offset:4096
  v_mfma_f32_16x16x32_bf16 v[96:99], v[144:147], v[28:31], v[96:99]
  ds_read_b64_tr_b16 v[158:159], v243 offset:6144
  v_mfma_f32_16x16x32_bf16 v[112:115], v[144:147], v[32:35], v[112:115]
  buffer_load_dwordx4 v[8:11], v3, s[40:43], s69 offen offset:0 sc1
  v_mfma_f32_16x16x32_bf16 v[128:131], v[144:147], v[36:39], v[128:131]
  buffer_load_dwordx4 v[12:15], v3, s[40:43], s69 offen offset:1024 sc1
  s_waitcnt lgkmcnt(4)
  v_mfma_f32_16x16x32_bf16 v[84:87], v[148:151], v[24:27], v[84:87]
  ds_read_b64_tr_b16 v[144:145], v240 offset:8192
  v_mfma_f32_16x16x32_bf16 v[100:103], v[148:151], v[28:31], v[100:103]
  ds_read_b64_tr_b16 v[146:147], v240 offset:10240
  v_mfma_f32_16x16x32_bf16 v[116:119], v[148:151], v[32:35], v[116:119]
  buffer_load_dwordx4 v[16:19], v3, s[40:43], s69 offen offset:2048 sc1
  v_mfma_f32_16x16x32_bf16 v[132:135], v[148:151], v[36:39], v[132:135]
  buffer_load_dwordx4 v[20:23], v3, s[40:43], s69 offen offset:3072 sc1
  s_add_u32 s69, s69, 4096
  s_waitcnt lgkmcnt(4)
  v_mfma_f32_16x16x32_bf16 v[88:91], v[152:155], v[24:27], v[88:91]
  ds_read_b64_tr_b16 v[148:149], v241 offset:8192
  v_mfma_f32_16x16x32_bf16 v[104:107], v[152:155], v[28:31], v[104:107]
  ds_read_b64_tr_b16 v[150:151], v241 offset:10240
  v_mfma_f32_16x16x32_bf16 v[120:123], v[152:155], v[32:35], v[120:123]
  v_mfma_f32_16x16x32_bf16 v[136:139], v[152:155], v[36:39], v[136:139]
  s_waitcnt lgkmcnt(4)
  v_mfma_f32_16x16x32_bf16 v[92:95], v[156:159], v[24:27], v[92:95]
  ds_read_b64_tr_b16 v[152:153], v242 offset:8192
  v_mfma_f32_16x16x32_bf16 v[108:111], v[156:159], v[28:31], v[108:111]
  ds_read_b64_tr_b16 v[154:155], v242 offset:10240
  v_mfma_f32_16x16x32_bf16 v[124:127], v[156:159], v[32:35], v[124:127]
  v_mfma_f32_16x16x32_bf16 v[140:143], v[156:159], v[36:39], v[140:143]
  s_waitcnt vmcnt(30)
  s_waitcnt lgkmcnt(4)
  v_mfma_f32_16x16x32_bf16 v[80:83], v[144:147], v[40:43], v[80:83]
  ds_read_b64_tr_b16 v[156:157], v243 offset:8192
  v_mfma_f32_16x16x32_bf16 v[96:99], v[144:147], v[44:47], v[96:99]
  ds_read_b64_tr_b16 v[158:159], v243 offset:10240
  v_mfma_f32_16x16x32_bf16 v[112:115], v[144:147], v[48:51], v[112:115]
  buffer_load_dwordx4 v[24:27], v3, s[40:43], s69 offen offset:0 sc1
  v_mfma_f32_16x16x32_bf16 v[128:131], v[144:147], v[52:55], v[128:131]
  buffer_load_dwordx4 v[28:31], v3, s[40:43], s69 offen offset:1024 sc1
  s_waitcnt lgkmcnt(4)
  v_mfma_f32_16x16x32_bf16 v[84:87], v[148:151], v[40:43], v[84:87]
  ds_read_b64_tr_b16 v[144:145], v240 offset:12288
  v_mfma_f32_16x16x32_bf16 v[100:103], v[148:151], v[44:47], v[100:103]
  ds_read_b64_tr_b16 v[146:147], v240 offset:14336
  v_mfma_f32_16x16x32_bf16 v[116:119], v[148:151], v[48:51], v[116:119]
  buffer_load_dwordx4 v[32:35], v3, s[40:43], s69 offen offset:2048 sc1
  v_mfma_f32_16x16x32_bf16 v[132:135], v[148:151], v[52:55], v[132:135]
  buffer_load_dwordx4 v[36:39], v3, s[40:43], s69 offen offset:3072 sc1
  s_add_u32 s69, s69, 4096
  s_waitcnt lgkmcnt(4)
  v_mfma_f32_16x16x32_bf16 v[88:91], v[152:155], v[40:43], v[88:91]
  ds_read_b64_tr_b16 v[148:149], v241 offset:12288
  v_mfma_f32_16x16x32_bf16 v[104:107], v[152:155], v[44:47], v[104:107]
  ds_read_b64_tr_b16 v[150:151], v241 offset:14336
  v_mfma_f32_16x16x32_bf16 v[120:123], v[152:155], v[48:51], v[120:123]
  v_mfma_f32_16x16x32_bf16 v[136:139], v[152:155], v[52:55], v[136:139]
  s_waitcnt lgkmcnt(4)
  v_mfma_f32_16x16x32_bf16 v[92:95], v[156:159], v[40:43], v[92:95]
  ds_read_b64_tr_b16 v[152:153], v242 offset:12288
  v_mfma_f32_16x16x32_bf16 v[108:111], v[156:159], v[44:47], v[108:111]
  ds_read_b64_tr_b16 v[154:155], v242 offset:14336
  v_mfma_f32_16x16x32_bf16 v[124:127], v[156:159], v[48:51], v[124:127]
  v_mfma_f32_16x16x32_bf16 v[140:143], v[156:159], v[52:55], v[140:143]
  s_waitcnt vmcnt(16)
  s_barrier
  s_waitcnt vmcnt(26)
  s_waitcnt lgkmcnt(4)
  v_mfma_f32_16x16x32_bf16 v[80:83], v[144:147], v[56:59], v[80:83]
  ds_read_b64_tr_b16 v[156:157], v243 offset:12288
  v_mfma_f32_16x16x32_bf16 v[96:99], v[144:147], v[60:63], v[96:99]
  ds_read_b64_tr_b16 v[158:159], v243 offset:14336
  v_mfma_f32_16x16x32_bf16 v[112:115], v[144:147], v[64:67], v[112:115]
  buffer_load_dwordx2 v[40:41], v4, s[40:43], s69 offen offset:0 sc1
  buffer_load_dwordx2 v[42:43], v4, s[40:43], s69 offen offset:512 sc1
  v_mfma_f32_16x16x32_bf16 v[128:131], v[144:147], v[68:71], v[128:131]
  buffer_load_dwordx2 v[44:45], v4, s[40:43], s69 offen offset:1024 sc1
  buffer_load_dwordx2 v[46:47], v4, s[40:43], s69 offen offset:1536 sc1
  s_waitcnt lgkmcnt(4)
  v_mfma_f32_16x16x32_bf16 v[84:87], v[148:151], v[56:59], v[84:87]
  ds_read_b64_tr_b16 v[144:145], v240 offset:16384
  v_mfma_f32_16x16x32_bf16 v[100:103], v[148:151], v[60:63], v[100:103]
  ds_read_b64_tr_b16 v[146:147], v240 offset:18432
  v_mfma_f32_16x16x32_bf16 v[116:119], v[148:151], v[64:67], v[116:119]
  buffer_load_dwordx2 v[48:49], v4, s[40:43], s69 offen offset:2048 sc1
  buffer_load_dwordx2 v[50:51], v4, s[40:43], s69 offen offset:2560 sc1
  v_mfma_f32_16x16x32_bf16 v[132:135], v[148:151], v[68:71], v[132:135]
  buffer_load_dwordx2 v[52:53], v4, s[40:43], s69 offen offset:3072 sc1
  buffer_load_dwordx2 v[54:55], v4, s[40:43], s69 offen offset:3584 sc1
  s_add_u32 s69, s69, 4096
  s_waitcnt lgkmcnt(4)
  v_mfma_f32_16x16x32_bf16 v[88:91], v[152:155], v[56:59], v[88:91]
  ds_read_b64_tr_b16 v[148:149], v241 offset:16384
  v_mfma_f32_16x16x32_bf16 v[104:107], v[152:155], v[60:63], v[104:107]
  ds_read_b64_tr_b16 v[150:151], v241 offset:18432
  v_mfma_f32_16x16x32_bf16 v[120:123], v[152:155], v[64:67], v[120:123]
  v_mfma_f32_16x16x32_bf16 v[136:139], v[152:155], v[68:71], v[136:139]
  s_waitcnt lgkmcnt(4)
  v_mfma_f32_16x16x32_bf16 v[92:95], v[156:159], v[56:59], v[92:95]
  ds_read_b64_tr_b16 v[152:153], v242 offset:16384
  v_mfma_f32_16x16x32_bf16 v[108:111], v[156:159], v[60:63], v[108:111]
  ds_read_b64_tr_b16 v[154:155], v242 offset:18432
  v_mfma_f32_16x16x32_bf16 v[124:127], v[156:159], v[64:67], v[124:127]
  v_mfma_f32_16x16x32_bf16 v[140:143], v[156:159], v[68:71], v[140:143]
  s_waitcnt vmcnt(30)
  s_waitcnt lgkmcnt(4)
  v_mfma_f32_16x16x32_bf16 v[80:83], v[144:147], v[160:163], v[80:83]
  ds_read_b64_tr_b16 v[156:157], v243 offset:16384
  v_mfma_f32_16x16x32_bf16 v[96:99], v[144:147], v[164:167], v[96:99]
  ds_read_b64_tr_b16 v[158:159], v243 offset:18432
  v_mfma_f32_16x16x32_bf16 v[112:115], v[144:147], v[168:171], v[112:115]
  buffer_load_dwordx4 v[56:59], v3, s[40:43], s69 offen offset:0 sc1
  v_mfma_f32_16x16x32_bf16 v[128:131], v[144:147], v[172:175], v[128:131]
  buffer_load_dwordx4 v[60:63], v3, s[40:43], s69 offen offset:1024 sc1
  s_waitcnt lgkmcnt(4)
  v_mfma_f32_16x16x32_bf16 v[84:87], v[148:151], v[160:163], v[84:87]
  ds_read_b64_tr_b16 v[144:145], v240 offset:20480
  v_mfma_f32_16x16x32_bf16 v[100:103], v[148:151], v[164:167], v[100:103]
  ds_read_b64_tr_b16 v[146:147], v240 offset:22528
  v_mfma_f32_16x16x32_bf16 v[116:119], v[148:151], v[168:171], v[116:119]
  buffer_load_dwordx4 v[64:67], v3, s[40:43], s69 offen offset:2048 sc1
  v_mfma_f32_16x16x32_bf16 v[132:135], v[148:151], v[172:175], v[132:135]
  buffer_load_dwordx4 v[68:71], v3, s[40:43], s69 offen offset:3072 sc1
  s_add_u32 s69, s69, 4096
  s_waitcnt lgkmcnt(4)
  v_mfma_f32_16x16x32_bf16 v[88:91], v[152:155], v[160:163], v[88:91]
  ds_read_b64_tr_b16 v[148:149], v241 offset:20480
  v_mfma_f32_16x16x32_bf16 v[104:107], v[152:155], v[164:167], v[104:107]
  ds_read_b64_tr_b16 v[150:151], v241 offset:22528
  v_mfma_f32_16x16x32_bf16 v[120:123], v[152:155], v[168:171], v[120:123]
  s_add_u32 m0, s71, 0
  s_add_u32 s55, s70, 262144
  buffer_load_dwordx4 v244, s[28:31], s55 offen lds
  v_mfma_f32_16x16x32_bf16 v[136:139], v[152:155], v[172:175], v[136:139]
  s_add_u32 m0, s71, 1024
  s_add_u32 s55, s70, 270336
  buffer_load_dwordx4 v244, s[28:31], s55 offen lds
  s_waitcnt lgkmcnt(4)
  v_mfma_f32_16x16x32_bf16 v[92:95], v[156:159], v[160:163], v[92:95]
  ds_read_b64_tr_b16 v[152:153], v242 offset:20480
  v_mfma_f32_16x16x32_bf16 v[108:111], v[156:159], v[164:167], v[108:111]
  ds_read_b64_tr_b16 v[154:155], v242 offset:22528
  v_mfma_f32_16x16x32_bf16 v[124:127], v[156:159], v[168:171], v[124:127]
  s_add_u32 m0, s71, 2048
  s_add_u32 s55, s70, 278528
  buffer_load_dwordx4 v244, s[28:31], s55 offen lds
  v_mfma_f32_16x16x32_bf16 v[140:143], v[156:159], v[172:175], v[140:143]
  s_add_u32 m0, s71, 3072
  s_add_u32 s55, s70, 286720
  buffer_load_dwordx4 v244, s[28:31], s55 offen lds
  s_waitcnt vmcnt(34)
  s_waitcnt lgkmcnt(4)
  v_mfma_f32_16x16x32_bf16 v[80:83], v[144:147], v[176:179], v[80:83]
  ds_read_b64_tr_b16 v[156:157], v243 offset:20480
  v_mfma_f32_16x16x32_bf16 v[96:99], v[144:147], v[180:183], v[96:99]
  ds_read_b64_tr_b16 v[158:159], v243 offset:22528
  v_mfma_f32_16x16x32_bf16 v[112:115], v[144:147], v[184:187], v[112:115]
  buffer_load_dwordx4 v[160:163], v3, s[40:43], s69 offen offset:0 sc1
  v_mfma_f32_16x16x32_bf16 v[128:131], v[144:147], v[188:191], v[128:131]
  buffer_load_dwordx4 v[164:167], v3, s[40:43], s69 offen offset:1024 sc1
  s_waitcnt lgkmcnt(4)
  v_mfma_f32_16x16x32_bf16 v[84:87], v[148:151], v[176:179], v[84:87]
  ds_read_b64_tr_b16 v[144:145], v240 offset:24576
  v_mfma_f32_16x16x32_bf16 v[100:103], v[148:151], v[180:183], v[100:103]
  ds_read_b64_tr_b16 v[146:147], v240 offset:26624
  v_mfma_f32_16x16x32_bf16 v[116:119], v[148:151], v[184:187], v[116:119]
  buffer_load_dwordx4 v[168:171], v3, s[40:43], s69 offen offset:2048 sc1
  v_mfma_f32_16x16x32_bf16 v[132:135], v[148:151], v[188:191], v[132:135]
  buffer_load_dwordx4 v[172:175], v3, s[40:43], s69 offen offset:3072 sc1
  s_add_u32 s69, s69, 4096
  s_waitcnt lgkmcnt(4)
  v_mfma_f32_16x16x32_bf16 v[88:91], v[152:155], v[176:179], v[88:91]
  ds_read_b64_tr_b16 v[148:149], v241 offset:24576
  v_mfma_f32_16x16x32_bf16 v[104:107], v[152:155], v[180:183], v[104:107]
  ds_read_b64_tr_b16 v[150:151], v241 offset:26624
  v_mfma_f32_16x16x32_bf16 v[120:123], v[152:155], v[184:187], v[120:123]
  s_add_u32 m0, s71, 4096
  s_add_u32 s55, s70, 294912
  buffer_load_dwordx4 v244, s[28:31], s55 offen lds
  v_mfma_f32_16x16x32_bf16 v[136:139], v[152:155], v[188:191], v[136:139]
  s_add_u32 m0, s71, 5120
  s_add_u32 s55, s70, 303104
  buffer_load_dwordx4 v244, s[28:31], s55 offen lds
  s_waitcnt lgkmcnt(4)
  v_mfma_f32_16x16x32_bf16 v[92:95], v[156:159], v[176:179], v[92:95]
  ds_read_b64_tr_b16 v[152:153], v242 offset:24576
  v_mfma_f32_16x16x32_bf16 v[108:111], v[156:159], v[180:183], v[108:111]
  ds_read_b64_tr_b16 v[154:155], v242 offset:26624
  v_mfma_f32_16x16x32_bf16 v[124:127], v[156:159], v[184:187], v[124:127]
  s_add_u32 m0, s71, 6144
  s_add_u32 s55, s70, 311296
  buffer_load_dwordx4 v244, s[28:31], s55 offen lds
  v_mfma_f32_16x16x32_bf16 v[140:143], v[156:159], v[188:191], v[140:143]
  s_add_u32 m0, s71, 7168
  s_add_u32 s55, s70, 319488
  buffer_load_dwordx4 v244, s[28:31], s55 offen lds
  s_waitcnt vmcnt(36)
  s_waitcnt lgkmcnt(4)
  v_mfma_f32_16x16x32_bf16 v[80:83], v[144:147], v[192:195], v[80:83]
  ds_read_b64_tr_b16 v[156:157], v243 offset:24576
  v_mfma_f32_16x16x32_bf16 v[96:99], v[144:147], v[196:199], v[96:99]
  ds_read_b64_tr_b16 v[158:159], v243 offset:26624
  v_mfma_f32_16x16x32_bf16 v[112:115], v[144:147], v[200:203], v[112:115]
  buffer_load_dwordx4 v[176:179], v3, s[40:43], s69 offen offset:0 sc1
  v_mfma_f32_16x16x32_bf16 v[128:131], v[144:147], v[204:207], v[128:131]
  buffer_load_dwordx4 v[180:183], v3, s[40:43], s69 offen offset:1024 sc1
  s_waitcnt lgkmcnt(4)
  v_mfma_f32_16x16x32_bf16 v[84:87], v[148:151], v[192:195], v[84:87]
  ds_read_b64_tr_b16 v[144:145], v240 offset:28672
  v_mfma_f32_16x16x32_bf16 v[100:103], v[148:151], v[196:199], v[100:103]
  ds_read_b64_tr_b16 v[146:147], v240 offset:30720
  v_mfma_f32_16x16x32_bf16 v[116:119], v[148:151], v[200:203], v[116:119]
  buffer_load_dwordx4 v[184:187], v3, s[40:43], s69 offen offset:2048 sc1
  v_mfma_f32_16x16x32_bf16 v[132:135], v[148:151], v[204:207], v[132:135]
  buffer_load_dwordx4 v[188:191], v3, s[40:43], s69 offen offset:3072 sc1
  s_add_u32 s69, s69, 4096
  s_waitcnt lgkmcnt(4)
  v_mfma_f32_16x16x32_bf16 v[88:91], v[152:155], v[192:195], v[88:91]
  ds_read_b64_tr_b16 v[148:149], v241 offset:28672
  v_mfma_f32_16x16x32_bf16 v[104:107], v[152:155], v[196:199], v[104:107]
  ds_read_b64_tr_b16 v[150:151], v241 offset:30720
  v_mfma_f32_16x16x32_bf16 v[120:123], v[152:155], v[200:203], v[120:123]
  s_add_u32 m0, s71, 8192
  s_add_u32 s55, s70, 327680
  buffer_load_dwordx4 v244, s[28:31], s55 offen lds
  v_mfma_f32_16x16x32_bf16 v[136:139], v[152:155], v[204:207], v[136:139]
  s_add_u32 m0, s71, 9216
  s_add_u32 s55, s70, 335872
  buffer_load_dwordx4 v244, s[28:31], s55 offen lds
  s_waitcnt lgkmcnt(4)
  v_mfma_f32_16x16x32_bf16 v[92:95], v[156:159], v[192:195], v[92:95]
  ds_read_b64_tr_b16 v[152:153], v242 offset:28672
  v_mfma_f32_16x16x32_bf16 v[108:111], v[156:159], v[196:199], v[108:111]
  ds_read_b64_tr_b16 v[154:155], v242 offset:30720
  v_mfma_f32_16x16x32_bf16 v[124:127], v[156:159], v[200:203], v[124:127]
  s_add_u32 m0, s71, 10240
  s_add_u32 s55, s70, 344064
  buffer_load_dwordx4 v244, s[28:31], s55 offen lds
  v_mfma_f32_16x16x32_bf16 v[140:143], v[156:159], v[204:207], v[140:143]
  s_add_u32 m0, s71, 11264
  s_add_u32 s55, s70, 352256
  buffer_load_dwordx4 v244, s[28:31], s55 offen lds
  s_waitcnt vmcnt(40)
  s_waitcnt vmcnt(16)
  s_waitcnt lgkmcnt(4)
  v_mfma_f32_16x16x32_bf16 v[80:83], v[144:147], v[208:211], v[80:83]
  ds_read_b64_tr_b16 v[156:157], v243 offset:28672
  v_mfma_f32_16x16x32_bf16 v[96:99], v[144:147], v[212:215], v[96:99]
  ds_read_b64_tr_b16 v[158:159], v243 offset:30720
  v_mfma_f32_16x16x32_bf16 v[112:115], v[144:147], v[216:219], v[112:115]
  s_add_u32 m0, s71, 12288
  s_add_u32 s55, s70, 360448
  buffer_load_dwordx4 v244, s[28:31], s55 offen lds
  v_mfma_f32_16x16x32_bf16 v[128:131], v[144:147], v[220:223], v[128:131]
  s_add_u32 m0, s71, 13312
  s_add_u32 s55, s70, 368640
  buffer_load_dwordx4 v244, s[28:31], s55 offen lds
  s_waitcnt lgkmcnt(4)
  v_mfma_f32_16x16x32_bf16 v[84:87], v[148:151], v[208:211], v[84:87]
  ds_read_b64_tr_b16 v[144:145], v240 offset:0
  v_mfma_f32_16x16x32_bf16 v[100:103], v[148:151], v[212:215], v[100:103]
  ds_read_b64_tr_b16 v[146:147], v240 offset:2048
  v_mfma_f32_16x16x32_bf16 v[116:119], v[148:151], v[216:219], v[116:119]
  s_add_u32 m0, s71, 14336
  s_add_u32 s55, s70, 376832
  buffer_load_dwordx4 v244, s[28:31], s55 offen lds
  v_mfma_f32_16x16x32_bf16 v[132:135], v[148:151], v[220:223], v[132:135]
  s_add_u32 m0, s71, 15360
  s_add_u32 s55, s70, 385024
  buffer_load_dwordx4 v244, s[28:31], s55 offen lds
  s_waitcnt lgkmcnt(4)
  v_mfma_f32_16x16x32_bf16 v[88:91], v[152:155], v[208:211], v[88:91]
  ds_read_b64_tr_b16 v[148:149], v241 offset:0
  v_mfma_f32_16x16x32_bf16 v[104:107], v[152:155], v[212:215], v[104:107]
  ds_read_b64_tr_b16 v[150:151], v241 offset:2048
  v_mfma_f32_16x16x32_bf16 v[120:123], v[152:155], v[216:219], v[120:123]
  v_mfma_f32_16x16x32_bf16 v[136:139], v[152:155], v[220:223], v[136:139]
  s_waitcnt lgkmcnt(4)
  v_mfma_f32_16x16x32_bf16 v[92:95], v[156:159], v[208:211], v[92:95]
  ds_read_b64_tr_b16 v[152:153], v242 offset:0
  v_mfma_f32_16x16x32_bf16 v[108:111], v[156:159], v[212:215], v[108:111]
  ds_read_b64_tr_b16 v[154:155], v242 offset:2048
  v_mfma_f32_16x16x32_bf16 v[124:127], v[156:159], v[216:219], v[124:127]
  v_mfma_f32_16x16x32_bf16 v[140:143], v[156:159], v[220:223], v[140:143]
  s_waitcnt vmcnt(40)
  s_waitcnt vmcnt(12)
  s_waitcnt lgkmcnt(4)
  v_mfma_f32_16x16x32_bf16 v[80:83], v[144:147], v[8:11], v[80:83]
  ds_read_b64_tr_b16 v[156:157], v243 offset:0
  v_mfma_f32_16x16x32_bf16 v[96:99], v[144:147], v[12:15], v[96:99]
  ds_read_b64_tr_b16 v[158:159], v243 offset:2048
  v_mfma_f32_16x16x32_bf16 v[112:115], v[144:147], v[16:19], v[112:115]
  s_add_u32 m0, s71, 16384
  s_add_u32 s55, s70, 393216
  buffer_load_dwordx4 v244, s[28:31], s55 offen lds
  v_mfma_f32_16x16x32_bf16 v[128:131], v[144:147], v[20:23], v[128:131]
  s_add_u32 m0, s71, 17408
  s_add_u32 s55, s70, 401408
  buffer_load_dwordx4 v244, s[28:31], s55 offen lds
  s_waitcnt lgkmcnt(4)
  v_mfma_f32_16x16x32_bf16 v[84:87], v[148:151], v[8:11], v[84:87]
  ds_read_b64_tr_b16 v[144:145], v240 offset:4096
  v_mfma_f32_16x16x32_bf16 v[100:103], v[148:151], v[12:15], v[100:103]
  ds_read_b64_tr_b16 v[146:147], v240 offset:6144
  v_mfma_f32_16x16x32_bf16 v[116:119], v[148:151], v[16:19], v[116:119]
  s_add_u32 m0, s71, 18432
  s_add_u32 s55, s70, 409600
  buffer_load_dwordx4 v244, s[28:31], s55 offen lds
  v_mfma_f32_16x16x32_bf16 v[132:135], v[148:151], v[20:23], v[132:135]
  s_add_u32 m0, s71, 19456
  s_add_u32 s55, s70, 417792
  buffer_load_dwordx4 v244, s[28:31], s55 offen lds
  s_waitcnt lgkmcnt(4)
  v_mfma_f32_16x16x32_bf16 v[88:91], v[152:155], v[8:11], v[88:91]
  ds_read_b64_tr_b16 v[148:149], v241 offset:4096
  v_mfma_f32_16x16x32_bf16 v[104:107], v[152:155], v[12:15], v[104:107]
  ds_read_b64_tr_b16 v[150:151], v241 offset:6144
  v_mfma_f32_16x16x32_bf16 v[120:123], v[152:155], v[16:19], v[120:123]
  v_mfma_f32_16x16x32_bf16 v[136:139], v[152:155], v[20:23], v[136:139]
  s_waitcnt lgkmcnt(4)
  v_mfma_f32_16x16x32_bf16 v[92:95], v[156:159], v[8:11], v[92:95]
  ds_read_b64_tr_b16 v[152:153], v242 offset:4096
  v_mfma_f32_16x16x32_bf16 v[108:111], v[156:159], v[12:15], v[108:111]
  ds_read_b64_tr_b16 v[154:155], v242 offset:6144
  v_mfma_f32_16x16x32_bf16 v[124:127], v[156:159], v[16:19], v[124:127]
  v_mfma_f32_16x16x32_bf16 v[140:143], v[156:159], v[20:23], v[140:143]
  s_waitcnt vmcnt(40)
  s_waitcnt vmcnt(8)
  s_waitcnt lgkmcnt(4)
  v_mfma_f32_16x16x32_bf16 v[80:83], v[144:147], v[24:27], v[80:83]
  ds_read_b64_tr_b16 v[156:157], v243 offset:4096
  v_mfma_f32_16x16x32_bf16 v[96:99], v[144:147], v[28:31], v[96:99]
  ds_read_b64_tr_b16 v[158:159], v243 offset:6144
  v_mfma_f32_16x16x32_bf16 v[112:115], v[144:147], v[32:35], v[112:115]
  s_add_u32 m0, s71, 20480
  s_add_u32 s55, s70, 425984
  buffer_load_dwordx4 v244, s[28:31], s55 offen lds
  v_mfma_f32_16x16x32_bf16 v[128:131], v[144:147], v[36:39], v[128:131]
  s_add_u32 m0, s71, 21504
  s_add_u32 s55, s70, 434176
  buffer_load_dwordx4 v244, s[28:31], s55 offen lds
  s_waitcnt lgkmcnt(4)
  v_mfma_f32_16x16x32_bf16 v[84:87], v[148:151], v[24:27], v[84:87]
  ds_read_b64_tr_b16 v[144:145], v240 offset:8192
  v_mfma_f32_16x16x32_bf16 v[100:103], v[148:151], v[28:31], v[100:103]
  ds_read_b64_tr_b16 v[146:147], v240 offset:10240
  v_mfma_f32_16x16x32_bf16 v[116:119], v[148:151], v[32:35], v[116:119]
  s_add_u32 m0, s71, 22528
  s_add_u32 s55, s70, 442368
  buffer_load_dwordx4 v244, s[28:31], s55 offen lds
  v_mfma_f32_16x16x32_bf16 v[132:135], v[148:151], v[36:39], v[132:135]
  s_add_u32 m0, s71, 23552
  s_add_u32 s55, s70, 450560
  buffer_load_dwordx4 v244, s[28:31], s55 offen lds
  s_waitcnt lgkmcnt(4)
  v_mfma_f32_16x16x32_bf16 v[88:91], v[152:155], v[24:27], v[88:91]
  ds_read_b64_tr_b16 v[148:149], v241 offset:8192
  v_mfma_f32_16x16x32_bf16 v[104:107], v[152:155], v[28:31], v[104:107]
  ds_read_b64_tr_b16 v[150:151], v241 offset:10240
  v_mfma_f32_16x16x32_bf16 v[120:123], v[152:155], v[32:35], v[120:123]
  v_mfma_f32_16x16x32_bf16 v[136:139], v[152:155], v[36:39], v[136:139]
  s_waitcnt lgkmcnt(4)
  v_mfma_f32_16x16x32_bf16 v[92:95], v[156:159], v[24:27], v[92:95]
  ds_read_b64_tr_b16 v[152:153], v242 offset:8192
  v_mfma_f32_16x16x32_bf16 v[108:111], v[156:159], v[28:31], v[108:111]
  ds_read_b64_tr_b16 v[154:155], v242 offset:10240
  v_mfma_f32_16x16x32_bf16 v[124:127], v[156:159], v[32:35], v[124:127]
  v_mfma_f32_16x16x32_bf16 v[140:143], v[156:159], v[36:39], v[140:143]
  s_waitcnt vmcnt(36)
  s_waitcnt vmcnt(8)
  s_waitcnt lgkmcnt(4)
  v_mfma_f32_16x16x32_bf16 v[80:83], v[144:147], v[40:43], v[80:83]
  ds_read_b64_tr_b16 v[156:157], v243 offset:8192
  v_mfma_f32_16x16x32_bf16 v[96:99], v[144:147], v[44:47], v[96:99]
  ds_read_b64_tr_b16 v[158:159], v243 offset:10240
  v_mfma_f32_16x16x32_bf16 v[112:115], v[144:147], v[48:51], v[112:115]
  v_mfma_f32_16x16x32_bf16 v[128:131], v[144:147], v[52:55], v[128:131]
  s_waitcnt lgkmcnt(4)
  v_mfma_f32_16x16x32_bf16 v[84:87], v[148:151], v[40:43], v[84:87]
  ds_read_b64_tr_b16 v[144:145], v240 offset:12288
  v_mfma_f32_16x16x32_bf16 v[100:103], v[148:151], v[44:47], v[100:103]
  ds_read_b64_tr_b16 v[146:147], v240 offset:14336
  v_mfma_f32_16x16x32_bf16 v[116:119], v[148:151], v[48:51], v[116:119]
  v_mfma_f32_16x16x32_bf16 v[132:135], v[148:151], v[52:55], v[132:135]
  s_waitcnt lgkmcnt(4)
  v_mfma_f32_16x16x32_bf16 v[88:91], v[152:155], v[40:43], v[88:91]
  ds_read_b64_tr_b16 v[148:149], v241 offset:12288
  v_mfma_f32_16x16x32_bf16 v[104:107], v[152:155], v[44:47], v[104:107]
  ds_read_b64_tr_b16 v[150:151], v241 offset:14336
  v_mfma_f32_16x16x32_bf16 v[120:123], v[152:155], v[48:51], v[120:123]
  v_mfma_f32_16x16x32_bf16 v[136:139], v[152:155], v[52:55], v[136:139]
  s_waitcnt lgkmcnt(4)
  v_mfma_f32_16x16x32_bf16 v[92:95], v[156:159], v[40:43], v[92:95]
  ds_read_b64_tr_b16 v[152:153], v242 offset:12288
  v_mfma_f32_16x16x32_bf16 v[108:111], v[156:159], v[44:47], v[108:111]
  ds_read_b64_tr_b16 v[154:155], v242 offset:14336
  v_mfma_f32_16x16x32_bf16 v[124:127], v[156:159], v[48:51], v[124:127]
  v_mfma_f32_16x16x32_bf16 v[140:143], v[156:159], v[52:55], v[140:143]
  s_waitcnt vmcnt(32)
  s_waitcnt vmcnt(4)
  s_waitcnt lgkmcnt(4)
  v_mfma_f32_16x16x32_bf16 v[80:83], v[144:147], v[56:59], v[80:83]
  ds_read_b64_tr_b16 v[156:157], v243 offset:12288
  v_mfma_f32_16x16x32_bf16 v[96:99], v[144:147], v[60:63], v[96:99]
  ds_read_b64_tr_b16 v[158:159], v243 offset:14336
  v_mfma_f32_16x16x32_bf16 v[112:115], v[144:147], v[64:67], v[112:115]
  v_mfma_f32_16x16x32_bf16 v[128:131], v[144:147], v[68:71], v[128:131]
  s_waitcnt lgkmcnt(4)
  v_mfma_f32_16x16x32_bf16 v[84:87], v[148:151], v[56:59], v[84:87]
  ds_read_b64_tr_b16 v[144:145], v240 offset:16384
  v_mfma_f32_16x16x32_bf16 v[100:103], v[148:151], v[60:63], v[100:103]
  ds_read_b64_tr_b16 v[146:147], v240 offset:18432
  v_mfma_f32_16x16x32_bf16 v[116:119], v[148:151], v[64:67], v[116:119]
  v_mfma_f32_16x16x32_bf16 v[132:135], v[148:151], v[68:71], v[132:135]
  s_waitcnt lgkmcnt(4)
  v_mfma_f32_16x16x32_bf16 v[88:91], v[152:155], v[56:59], v[88:91]
  ds_read_b64_tr_b16 v[148:149], v241 offset:16384
  v_mfma_f32_16x16x32_bf16 v[104:107], v[152:155], v[60:63], v[104:107]
  ds_read_b64_tr_b16 v[150:151], v241 offset:18432
  v_mfma_f32_16x16x32_bf16 v[120:123], v[152:155], v[64:67], v[120:123]
  v_mfma_f32_16x16x32_bf16 v[136:139], v[152:155], v[68:71], v[136:139]
  s_waitcnt lgkmcnt(4)
  v_mfma_f32_16x16x32_bf16 v[92:95], v[156:159], v[56:59], v[92:95]
  ds_read_b64_tr_b16 v[152:153], v242 offset:16384
  v_mfma_f32_16x16x32_bf16 v[108:111], v[156:159], v[60:63], v[108:111]
  ds_read_b64_tr_b16 v[154:155], v242 offset:18432
  v_mfma_f32_16x16x32_bf16 v[124:127], v[156:159], v[64:67], v[124:127]
  v_mfma_f32_16x16x32_bf16 v[140:143], v[156:159], v[68:71], v[140:143]
  s_mov_b32 s93, 4212736
  s_cmp_lg_u32 s3, 0
  s_cbranch_scc1 L_pw3684
  v_mul_u32_u24 v251, 128, v0
  s_mov_b64 exec, 0xff
  s_mov_b32 s94, 0
L_poll3686:
  buffer_load_dword v250, v251, s[40:43], s93 offen sc1
  s_add_u32 s94, s94, 1
  s_waitcnt vmcnt(0)
  v_cmp_gt_u32 vcc, 32, v250
  s_nop 4
  s_cbranch_vccz L_poll3686_done
  s_cmp_gt_u32 s94, 50000
  s_cbranch_scc1 L_poll3686_done
  s_sleep 16
  s_branch L_poll3686
L_poll3686_done:
  s_mov_b64 exec, -1
L_pw3684:
  s_barrier
  s_add_u32 s75, s74, 4202496
  buffer_load_dwordx4 v[72:75], v5, s[40:43], s75 offen sc1
  s_waitcnt vmcnt(25)
  s_waitcnt vmcnt(1)
  s_waitcnt lgkmcnt(4)
  v_mfma_f32_16x16x32_bf16 v[80:83], v[144:147], v[160:163], v[80:83]
  ds_read_b64_tr_b16 v[156:157], v243 offset:16384
  v_mfma_f32_16x16x32_bf16 v[96:99], v[144:147], v[164:167], v[96:99]
  ds_read_b64_tr_b16 v[158:159], v243 offset:18432
  v_mfma_f32_16x16x32_bf16 v[112:115], v[144:147], v[168:171], v[112:115]
  s_add_u32 s79, s78, 0
  buffer_load_dwordx4 v[192:195], v6, s[40:43], s79 offen sc1
  v_mfma_f32_16x16x32_bf16 v[128:131], v[144:147], v[172:175], v[128:131]
  s_add_u32 s79, s78, 8192
  buffer_load_dwordx4 v[196:199], v6, s[40:43], s79 offen sc1
  s_waitcnt lgkmcnt(4)
  v_mfma_f32_16x16x32_bf16 v[84:87], v[148:151], v[160:163], v[84:87]
  ds_read_b64_tr_b16 v[144:145], v240 offset:20480
  v_mfma_f32_16x16x32_bf16 v[100:103], v[148:151], v[164:167], v[100:103]
  ds_read_b64_tr_b16 v[146:147], v240 offset:22528
  v_mfma_f32_16x16x32_bf16 v[116:119], v[148:151], v[168:171], v[116:119]
  s_add_u32 s79, s78, 16384
  buffer_load_dwordx4 v[200:203], v6, s[40:43], s79 offen sc1
  v_mfma_f32_16x16x32_bf16 v[132:135], v[148:151], v[172:175], v[132:135]
  s_add_u32 s79, s78, 24576
  buffer_load_dwordx4 v[204:207], v6, s[40:43], s79 offen sc1
  s_waitcnt lgkmcnt(4)
  v_mfma_f32_16x16x32_bf16 v[88:91], v[152:155], v[160:163], v[88:91]
  ds_read_b64_tr_b16 v[148:149], v241 offset:20480
  v_mfma_f32_16x16x32_bf16 v[104:107], v[152:155], v[164:167], v[104:107]
  ds_read_b64_tr_b16 v[150:151], v241 offset:22528
  v_mfma_f32_16x16x32_bf16 v[120:123], v[152:155], v[168:171], v[120:123]
  s_add_u32 s79, s78, 131072
  buffer_load_dwordx4 v[208:211], v6, s[40:43], s79 offen sc1
  v_mfma_f32_16x16x32_bf16 v[136:139], v[152:155], v[172:175], v[136:139]
  s_add_u32 s79, s78, 139264
  buffer_load_dwordx4 v[212:215], v6, s[40:43], s79 offen sc1
  s_waitcnt lgkmcnt(4)
  v_mfma_f32_16x16x32_bf16 v[92:95], v[156:159], v[160:163], v[92:95]
  ds_read_b64_tr_b16 v[152:153], v242 offset:20480
  v_mfma_f32_16x16x32_bf16 v[108:111], v[156:159], v[164:167], v[108:111]
  ds_read_b64_tr_b16 v[154:155], v242 offset:22528
  v_mfma_f32_16x16x32_bf16 v[124:127], v[156:159], v[168:171], v[124:127]
  s_add_u32 s79, s78, 147456
  buffer_load_dwordx4 v[216:219], v6, s[40:43], s79 offen sc1
  v_mfma_f32_16x16x32_bf16 v[140:143], v[156:159], v[172:175], v[140:143]
  s_add_u32 s79, s78, 155648
  buffer_load_dwordx4 v[220:223], v6, s[40:43], s79 offen sc1
  s_waitcnt vmcnt(25)
  s_waitcnt lgkmcnt(4)
  v_mfma_f32_16x16x32_bf16 v[80:83], v[144:147], v[176:179], v[80:83]
  ds_read_b64_tr_b16 v[156:157], v243 offset:20480
  v_mfma_f32_16x16x32_bf16 v[96:99], v[144:147], v[180:183], v[96:99]
  ds_read_b64_tr_b16 v[158:159], v243 offset:22528
  v_mfma_f32_16x16x32_bf16 v[112:115], v[144:147], v[184:187], v[112:115]
  s_add_u32 s79, s78, 262144
  buffer_load_dwordx4 v[8:11], v6, s[40:43], s79 offen sc1
  v_mfma_f32_16x16x32_bf16 v[128:131], v[144:147], v[188:191], v[128:131]
  s_add_u32 s79, s78, 270336
  buffer_load_dwordx4 v[12:15], v6, s[40:43], s79 offen sc1
  s_waitcnt lgkmcnt(4)
  v_mfma_f32_16x16x32_bf16 v[84:87], v[148:151], v[176:179], v[84:87]
  v_mfma_f32_16x16x32_bf16 v[100:103], v[148:151], v[180:183], v[100:103]
  v_mfma_f32_16x16x32_bf16 v[116:119], v[148:151], v[184:187], v[116:119]
  s_add_u32 s79, s78, 278528
  buffer_load_dwordx4 v[16:19], v6, s[40:43], s79 offen sc1
  v_mfma_f32_16x16x32_bf16 v[132:135], v[148:151], v[188:191], v[132:135]
  s_add_u32 s79, s78, 286720
  buffer_load_dwordx4 v[20:23], v6, s[40:43], s79 offen sc1
  s_waitcnt lgkmcnt(2)
  v_mfma_f32_16x16x32_bf16 v[88:91], v[152:155], v[176:179], v[88:91]
  v_mfma_f32_16x16x32_bf16 v[104:107], v[152:155], v[180:183], v[104:107]
  v_mfma_f32_16x16x32_bf16 v[120:123], v[152:155], v[184:187], v[120:123]
  s_add_u32 s79, s78, 393216
  buffer_load_dwordx4 v[24:27], v6, s[40:43], s79 offen sc1
  v_mfma_f32_16x16x32_bf16 v[136:139], v[152:155], v[188:191], v[136:139]
  s_add_u32 s79, s78, 401408
  buffer_load_dwordx4 v[28:31], v6, s[40:43], s79 offen sc1
  s_waitcnt lgkmcnt(0)
  v_mfma_f32_16x16x32_bf16 v[92:95], v[156:159], v[176:179], v[92:95]
  v_mfma_f32_16x16x32_bf16 v[108:111], v[156:159], v[180:183], v[108:111]
  v_mfma_f32_16x16x32_bf16 v[124:127], v[156:159], v[184:187], v[124:127]
  s_add_u32 s79, s78, 409600
  buffer_load_dwordx4 v[32:35], v6, s[40:43], s79 offen sc1
  v_mfma_f32_16x16x32_bf16 v[140:143], v[156:159], v[188:191], v[140:143]
  s_add_u32 s79, s78, 417792
  buffer_load_dwordx4 v[36:39], v6, s[40:43], s79 offen sc1
  s_barrier
  ds_read_b128 v[224:227], v7 offset:24576
  ds_read_b128 v[228:231], v7 offset:25600
  ds_read_b128 v[232:235], v7 offset:26624
  ds_read_b128 v[236:239], v7 offset:27648
  s_waitcnt vmcnt(12)
  v_swap_b32 v193, v196
  v_swap_b32 v194, v200
  v_swap_b32 v195, v204
  v_swap_b32 v198, v201
  v_swap_b32 v199, v205
  v_swap_b32 v203, v206
  s_waitcnt lgkmcnt(3)
  v_mfma_f32_16x16x32_bf16 v[40:43], v[224:227], v[192:195], 0
  ds_read_b128 v[144:147], v7 offset:28672
  ds_read_b128 v[148:151], v7 offset:29696
  ds_read_b128 v[152:155], v7 offset:30720
  ds_read_b128 v[156:159], v7 offset:31744
  v_mfma_f32_16x16x32_bf16 v[56:59], v[224:227], v[196:199], 0
  v_mfma_f32_16x16x32_bf16 v[160:163], v[224:227], v[200:203], 0
  v_mfma_f32_16x16x32_bf16 v[176:179], v[224:227], v[204:207], 0
  s_waitcnt lgkmcnt(6)
  v_mfma_f32_16x16x32_bf16 v[44:47], v[228:231], v[192:195], 0
  s_waitcnt vmcnt(8)
  v_swap_b32 v209, v212
  v_swap_b32 v210, v216
  v_swap_b32 v211, v220
  v_swap_b32 v214, v217
  v_swap_b32 v215, v221
  v_swap_b32 v219, v222
  v_mfma_f32_16x16x32_bf16 v[60:63], v[228:231], v[196:199], 0
  v_mfma_f32_16x16x32_bf16 v[164:167], v[228:231], v[200:203], 0
  v_mfma_f32_16x16x32_bf16 v[180:183], v[228:231], v[204:207], 0
  s_waitcnt lgkmcnt(5)
  v_mfma_f32_16x16x32_bf16 v[48:51], v[232:235], v[192:195], 0
  v_mfma_f32_16x16x32_bf16 v[64:67], v[232:235], v[196:199], 0
  v_mfma_f32_16x16x32_bf16 v[168:171], v[232:235], v[200:203], 0
  v_mfma_f32_16x16x32_bf16 v[184:187], v[232:235], v[204:207], 0
  s_waitcnt lgkmcnt(4)
  v_mfma_f32_16x16x32_bf16 v[52:55], v[236:239], v[192:195], 0
  v_mfma_f32_16x16x32_bf16 v[68:71], v[236:239], v[196:199], 0
  v_mfma_f32_16x16x32_bf16 v[172:175], v[236:239], v[200:203], 0
  v_mfma_f32_16x16x32_bf16 v[188:191], v[236:239], v[204:207], 0
  s_waitcnt lgkmcnt(3)
  v_mfma_f32_16x16x32_bf16 v[40:43], v[144:147], v[208:211], v[40:43]
  ds_read_b128 v[224:227], v7 offset:0
  ds_read_b128 v[228:231], v7 offset:1024
  ds_read_b128 v[232:235], v7 offset:2048
  ds_read_b128 v[236:239], v7 offset:3072
  v_mfma_f32_16x16x32_bf16 v[56:59], v[144:147], v[212:215], v[56:59]
  v_mfma_f32_16x16x32_bf16 v[160:163], v[144:147], v[216:219], v[160:163]
  v_mfma_f32_16x16x32_bf16 v[176:179], v[144:147], v[220:223], v[176:179]
  s_waitcnt lgkmcnt(6)
  v_mfma_f32_16x16x32_bf16 v[44:47], v[148:151], v[208:211], v[44:47]
  s_waitcnt vmcnt(4)
  v_swap_b32 v9, v12
  v_swap_b32 v10, v16
  v_swap_b32 v11, v20
  v_swap_b32 v14, v17
  v_swap_b32 v15, v21
  v_swap_b32 v19, v22
  v_mfma_f32_16x16x32_bf16 v[60:63], v[148:151], v[212:215], v[60:63]
  v_mfma_f32_16x16x32_bf16 v[164:167], v[148:151], v[216:219], v[164:167]
  v_mfma_f32_16x16x32_bf16 v[180:183], v[148:151], v[220:223], v[180:183]
  s_waitcnt lgkmcnt(5)
  v_mfma_f32_16x16x32_bf16 v[48:51], v[152:155], v[208:211], v[48:51]
  v_mfma_f32_16x16x32_bf16 v[64:67], v[152:155], v[212:215], v[64:67]
  v_mfma_f32_16x16x32_bf16 v[168:171], v[152:155], v[216:219], v[168:171]
  v_mfma_f32_16x16x32_bf16 v[184:187], v[152:155], v[220:223], v[184:187]
  s_waitcnt lgkmcnt(4)
  v_mfma_f32_16x16x32_bf16 v[52:55], v[156:159], v[208:211], v[52:55]
  v_mfma_f32_16x16x32_bf16 v[68:71], v[156:159], v[212:215], v[68:71]
  v_mfma_f32_16x16x32_bf16 v[172:175], v[156:159], v[216:219], v[172:175]
  v_mfma_f32_16x16x32_bf16 v[188:191], v[156:159], v[220:223], v[188:191]
  s_waitcnt lgkmcnt(3)
  v_mfma_f32_16x16x32_bf16 v[40:43], v[224:227], v[8:11], v[40:43]
  ds_read_b128 v[144:147], v7 offset:4096
  ds_read_b128 v[148:151], v7 offset:5120
  ds_read_b128 v[152:155], v7 offset:6144
  ds_read_b128 v[156:159], v7 offset:7168
  v_mfma_f32_16x16x32_bf16 v[56:59], v[224:227], v[12:15], v[56:59]
  v_mfma_f32_16x16x32_bf16 v[160:163], v[224:227], v[16:19], v[160:163]
  v_mfma_f32_16x16x32_bf16 v[176:179], v[224:227], v[20:23], v[176:179]
  s_waitcnt lgkmcnt(6)
  v_mfma_f32_16x16x32_bf16 v[44:47], v[228:231], v[8:11], v[44:47]
  s_waitcnt vmcnt(0)
  v_swap_b32 v25, v28
  v_swap_b32 v26, v32
  v_swap_b32 v27, v36
  v_swap_b32 v30, v33
  v_swap_b32 v31, v37
  v_swap_b32 v35, v38
  v_mfma_f32_16x16x32_bf16 v[60:63], v[228:231], v[12:15], v[60:63]
  v_mfma_f32_16x16x32_bf16 v[164:167], v[228:231], v[16:19], v[164:167]
  v_mfma_f32_16x16x32_bf16 v[180:183], v[228:231], v[20:23], v[180:183]
  s_waitcnt lgkmcnt(5)
  v_mfma_f32_16x16x32_bf16 v[48:51], v[232:235], v[8:11], v[48:51]
  v_mfma_f32_16x16x32_bf16 v[64:67], v[232:235], v[12:15], v[64:67]
  v_mfma_f32_16x16x32_bf16 v[168:171], v[232:235], v[16:19], v[168:171]
  v_mfma_f32_16x16x32_bf16 v[184:187], v[232:235], v[20:23], v[184:187]
  s_waitcnt lgkmcnt(4)
  v_mfma_f32_16x16x32_bf16 v[52:55], v[236:239], v[8:11], v[52:55]
  v_mfma_f32_16x16x32_bf16 v[68:71], v[236:239], v[12:15], v[68:71]
  v_mfma_f32_16x16x32_bf16 v[172:175], v[236:239], v[16:19], v[172:175]
  v_mfma_f32_16x16x32_bf16 v[188:191], v[236:239], v[20:23], v[188:191]
  s_waitcnt lgkmcnt(3)
  v_mfma_f32_16x16x32_bf16 v[40:43], v[144:147], v[24:27], v[40:43]
  v_mfma_f32_16x16x32_bf16 v[56:59], v[144:147], v[28:31], v[56:59]
  v_mfma_f32_16x16x32_bf16 v[160:163], v[144:147], v[32:35], v[160:163]
  v_mfma_f32_16x16x32_bf16 v[176:179], v[144:147], v[36:39], v[176:179]
  s_waitcnt lgkmcnt(2)
  v_mfma_f32_16x16x32_bf16 v[44:47], v[148:151], v[24:27], v[44:47]
  v_mfma_f32_16x16x32_bf16 v[60:63], v[148:151], v[28:31], v[60:63]
  v_mfma_f32_16x16x32_bf16 v[164:167], v[148:151], v[32:35], v[164:167]
  v_mfma_f32_16x16x32_bf16 v[180:183], v[148:151], v[36:39], v[180:183]
  s_waitcnt lgkmcnt(1)
  v_mfma_f32_16x16x32_bf16 v[48:51], v[152:155], v[24:27], v[48:51]
  v_mfma_f32_16x16x32_bf16 v[64:67], v[152:155], v[28:31], v[64:67]
  v_mfma_f32_16x16x32_bf16 v[168:171], v[152:155], v[32:35], v[168:171]
  v_mfma_f32_16x16x32_bf16 v[184:187], v[152:155], v[36:39], v[184:187]
  s_waitcnt lgkmcnt(0)
  v_mfma_f32_16x16x32_bf16 v[52:55], v[156:159], v[24:27], v[52:55]
  v_mfma_f32_16x16x32_bf16 v[68:71], v[156:159], v[28:31], v[68:71]
  v_mfma_f32_16x16x32_bf16 v[172:175], v[156:159], v[32:35], v[172:175]
  v_mfma_f32_16x16x32_bf16 v[188:191], v[156:159], v[36:39], v[188:191]
  s_waitcnt vmcnt(16)
  v_sub_f32 v72, 1.0, v72
  v_sub_f32 v73, 1.0, v73
  v_sub_f32 v74, 1.0, v74
  v_sub_f32 v75, 1.0, v75
  v_pk_fma_f32 v[80:81], v[80:81], v[72:73], v[40:41] op_sel:[0,0,0] op_sel_hi:[1,0,1]
  v_pk_fma_f32 v[82:83], v[82:83], v[72:73], v[42:43] op_sel:[0,0,0] op_sel_hi:[1,0,1]
  v_pk_fma_f32 v[84:85], v[84:85], v[72:73], v[44:45] op_sel:[0,0,0] op_sel_hi:[1,0,1]
  v_pk_fma_f32 v[86:87], v[86:87], v[72:73], v[46:47] op_sel:[0,0,0] op_sel_hi:[1,0,1]
  v_pk_fma_f32 v[88:89], v[88:89], v[72:73], v[48:49] op_sel:[0,0,0] op_sel_hi:[1,0,1]
  v_pk_fma_f32 v[90:91], v[90:91], v[72:73], v[50:51] op_sel:[0,0,0] op_sel_hi:[1,0,1]
  v_pk_fma_f32 v[92:93], v[92:93], v[72:73], v[52:53] op_sel:[0,0,0] op_sel_hi:[1,0,1]
  v_pk_fma_f32 v[94:95], v[94:95], v[72:73], v[54:55] op_sel:[0,0,0] op_sel_hi:[1,0,1]
  v_pk_fma_f32 v[96:97], v[96:97], v[72:73], v[56:57] op_sel:[0,1,0] op_sel_hi:[1,1,1]
  v_pk_fma_f32 v[98:99], v[98:99], v[72:73], v[58:59] op_sel:[0,1,0] op_sel_hi:[1,1,1]
  v_pk_fma_f32 v[100:101], v[100:101], v[72:73], v[60:61] op_sel:[0,1,0] op_sel_hi:[1,1,1]
  v_pk_fma_f32 v[102:103], v[102:103], v[72:73], v[62:63] op_sel:[0,1,0] op_sel_hi:[1,1,1]
  v_pk_fma_f32 v[104:105], v[104:105], v[72:73], v[64:65] op_sel:[0,1,0] op_sel_hi:[1,1,1]
  v_pk_fma_f32 v[106:107], v[106:107], v[72:73], v[66:67] op_sel:[0,1,0] op_sel_hi:[1,1,1]
  v_pk_fma_f32 v[108:109], v[108:109], v[72:73], v[68:69] op_sel:[0,1,0] op_sel_hi:[1,1,1]
  v_pk_fma_f32 v[110:111], v[110:111], v[72:73], v[70:71] op_sel:[0,1,0] op_sel_hi:[1,1,1]
  v_pk_fma_f32 v[112:113], v[112:113], v[74:75], v[160:161] op_sel:[0,0,0] op_sel_hi:[1,0,1]
  v_pk_fma_f32 v[114:115], v[114:115], v[74:75], v[162:163] op_sel:[0,0,0] op_sel_hi:[1,0,1]
  v_pk_fma_f32 v[116:117], v[116:117], v[74:75], v[164:165] op_sel:[0,0,0] op_sel_hi:[1,0,1]
  v_pk_fma_f32 v[118:119], v[118:119], v[74:75], v[166:167] op_sel:[0,0,0] op_sel_hi:[1,0,1]
  v_pk_fma_f32 v[120:121], v[120:121], v[74:75], v[168:169] op_sel:[0,0,0] op_sel_hi:[1,0,1]
  v_pk_fma_f32 v[122:123], v[122:123], v[74:75], v[170:171] op_sel:[0,0,0] op_sel_hi:[1,0,1]
  v_pk_fma_f32 v[124:125], v[124:125], v[74:75], v[172:173] op_sel:[0,0,0] op_sel_hi:[1,0,1]
  v_pk_fma_f32 v[126:127], v[126:127], v[74:75], v[174:175] op_sel:[0,0,0] op_sel_hi:[1,0,1]
  v_pk_fma_f32 v[128:129], v[128:129], v[74:75], v[176:177] op_sel:[0,1,0] op_sel_hi:[1,1,1]
  v_pk_fma_f32 v[130:131], v[130:131], v[74:75], v[178:179] op_sel:[0,1,0] op_sel_hi:[1,1,1]
  v_pk_fma_f32 v[132:133], v[132:133], v[74:75], v[180:181] op_sel:[0,1,0] op_sel_hi:[1,1,1]
  v_pk_fma_f32 v[134:135], v[134:135], v[74:75], v[182:183] op_sel:[0,1,0] op_sel_hi:[1,1,1]
  v_pk_fma_f32 v[136:137], v[136:137], v[74:75], v[184:185] op_sel:[0,1,0] op_sel_hi:[1,1,1]
  v_pk_fma_f32 v[138:139], v[138:139], v[74:75], v[186:187] op_sel:[0,1,0] op_sel_hi:[1,1,1]
  v_pk_fma_f32 v[140:141], v[140:141], v[74:75], v[188:189] op_sel:[0,1,0] op_sel_hi:[1,1,1]
  v_pk_fma_f32 v[142:143], v[142:143], v[74:75], v[190:191] op_sel:[0,1,0] op_sel_hi:[1,1,1]
  v_add_u32 v7, s71, v3
  s_cmp_lg_u32 s3, 0
  s_cbranch_scc1 L_k3_w0
  ds_write_b128 v7, v[96:99] offset:0
  ds_write_b128 v7, v[100:103] offset:1024
  ds_write_b128 v7, v[104:107] offset:2048
  ds_write_b128 v7, v[108:111] offset:3072
  ds_write_b128 v7, v[112:115] offset:4096
  ds_write_b128 v7, v[116:119] offset:5120
  ds_write_b128 v7, v[120:123] offset:6144
  ds_write_b128 v7, v[124:127] offset:7168
  ds_write_b128 v7, v[128:131] offset:8192
  ds_write_b128 v7, v[132:135] offset:9216
  ds_write_b128 v7, v[136:139] offset:10240
  ds_write_b128 v7, v[140:143] offset:11264
L_k3_w0:
  s_cmp_lg_u32 s3, 1
  s_cbranch_scc1 L_k3_w1
  ds_write_b128 v7, v[80:83] offset:0
  ds_write_b128 v7, v[84:87] offset:1024
  ds_write_b128 v7, v[88:91] offset:2048
  ds_write_b128 v7, v[92:95] offset:3072
  ds_write_b128 v7, v[112:115] offset:4096
  ds_write_b128 v7, v[116:119] offset:5120
  ds_write_b128 v7, v[120:123] offset:6144
  ds_write_b128 v7, v[124:127] offset:7168
  ds_write_b128 v7, v[128:131] offset:8192
  ds_write_b128 v7, v[132:135] offset:9216
  ds_write_b128 v7, v[136:139] offset:10240
  ds_write_b128 v7, v[140:143] offset:11264
  v_pk_mov_b32 v[80:81], v[96:97], v[96:97] op_sel:[0,1]
  v_pk_mov_b32 v[82:83], v[98:99], v[98:99] op_sel:[0,1]
  v_pk_mov_b32 v[84:85], v[100:101], v[100:101] op_sel:[0,1]
  v_pk_mov_b32 v[86:87], v[102:103], v[102:103] op_sel:[0,1]
  v_pk_mov_b32 v[88:89], v[104:105], v[104:105] op_sel:[0,1]
  v_pk_mov_b32 v[90:91], v[106:107], v[106:107] op_sel:[0,1]
  v_pk_mov_b32 v[92:93], v[108:109], v[108:109] op_sel:[0,1]
  v_pk_mov_b32 v[94:95], v[110:111], v[110:111] op_sel:[0,1]
L_k3_w1:
  s_cmp_lg_u32 s3, 2
  s_cbranch_scc1 L_k3_w2
  ds_write_b128 v7, v[80:83] offset:0
  ds_write_b128 v7, v[84:87] offset:1024
  ds_write_b128 v7, v[88:91] offset:2048
  ds_write_b128 v7, v[92:95] offset:3072
  ds_write_b128 v7, v[96:99] offset:4096
  ds_write_b128 v7, v[100:103] offset:5120
  ds_write_b128 v7, v[104:107] offset:6144
  ds_write_b128 v7, v[108:111] offset:7168
  ds_write_b128 v7, v[128:131] offset:8192
  ds_write_b128 v7, v[132:135] offset:9216
  ds_write_b128 v7, v[136:139] offset:10240
  ds_write_b128 v7, v[140:143] offset:11264
  v_pk_mov_b32 v[80:81], v[112:113], v[112:113] op_sel:[0,1]
  v_pk_mov_b32 v[82:83], v[114:115], v[114:115] op_sel:[0,1]
  v_pk_mov_b32 v[84:85], v[116:117], v[116:117] op_sel:[0,1]
  v_pk_mov_b32 v[86:87], v[118:119], v[118:119] op_sel:[0,1]
  v_pk_mov_b32 v[88:89], v[120:121], v[120:121] op_sel:[0,1]
  v_pk_mov_b32 v[90:91], v[122:123], v[122:123] op_sel:[0,1]
  v_pk_mov_b32 v[92:93], v[124:125], v[124:125] op_sel:[0,1]
  v_pk_mov_b32 v[94:95], v[126:127], v[126:127] op_sel:[0,1]
L_k3_w2:
  s_cmp_lg_u32 s3, 3
  s_cbranch_scc1 L_k3_w3
  ds_write_b128 v7, v[80:83] offset:0
  ds_write_b128 v7, v[84:87] offset:1024
  ds_write_b128 v7, v[88:91] offset:2048
  ds_write_b128 v7, v[92:95] offset:3072
  ds_write_b128 v7, v[96:99] offset:4096
  ds_write_b128 v7, v[100:103] offset:5120
  ds_write_b128 v7, v[104:107] offset:6144
  ds_write_b128 v7, v[108:111] offset:7168
  ds_write_b128 v7, v[112:115] offset:8192
  ds_write_b128 v7, v[116:119] offset:9216
  ds_write_b128 v7, v[120:123] offset:10240
  ds_write_b128 v7, v[124:127] offset:11264
  v_pk_mov_b32 v[80:81], v[128:129], v[128:129] op_sel:[0,1]
  v_pk_mov_b32 v[82:83], v[130:131], v[130:131] op_sel:[0,1]
  v_pk_mov_b32 v[84:85], v[132:133], v[132:133] op_sel:[0,1]
  v_pk_mov_b32 v[86:87], v[134:135], v[134:135] op_sel:[0,1]
  v_pk_mov_b32 v[88:89], v[136:137], v[136:137] op_sel:[0,1]
  v_pk_mov_b32 v[90:91], v[138:139], v[138:139] op_sel:[0,1]
  v_pk_mov_b32 v[92:93], v[140:141], v[140:141] op_sel:[0,1]
  v_pk_mov_b32 v[94:95], v[142:143], v[142:143] op_sel:[0,1]
L_k3_w3:
  s_waitcnt lgkmcnt(0)
  s_barrier
  s_add_u32 s76, s3, 1
  s_and_b32 s76, s76, 3
  s_lshl_b32 s77, s76, 15
  s_cmp_lt_u32 s3, s76
  s_cselect_b32 s79, 0, 1
  s_sub_u32 s79, s3, s79
  s_lshl_b32 s79, s79, 12
  s_add_u32 s77, s77, s79
  v_add_u32 v7, s77, v3
  ds_read_b128 v[160:163], v7 offset:0
  ds_read_b128 v[164:167], v7 offset:1024
  ds_read_b128 v[168:171], v7 offset:2048
  ds_read_b128 v[172:175], v7 offset:3072
  s_add_u32 s76, s3, 2
  s_and_b32 s76, s76, 3
  s_lshl_b32 s77, s76, 15
  s_cmp_lt_u32 s3, s76
  s_cselect_b32 s79, 0, 1
  s_sub_u32 s79, s3, s79
  s_lshl_b32 s79, s79, 12
  s_add_u32 s77, s77, s79
  v_add_u32 v7, s77, v3
  ds_read_b128 v[176:179], v7 offset:0
  ds_read_b128 v[180:183], v7 offset:1024
  ds_read_b128 v[184:187], v7 offset:2048
  ds_read_b128 v[188:191], v7 offset:3072
  s_add_u32 s76, s3, 3
  s_and_b32 s76, s76, 3
  s_lshl_b32 s77, s76, 15
  s_cmp_lt_u32 s3, s76
  s_cselect_b32 s79, 0, 1
  s_sub_u32 s79, s3, s79
  s_lshl_b32 s79, s79, 12
  s_add_u32 s77, s77, s79
  v_add_u32 v7, s77, v3
  ds_read_b128 v[192:195], v7 offset:0
  ds_read_b128 v[196:199], v7 offset:1024
  ds_read_b128 v[200:203], v7 offset:2048
  ds_read_b128 v[204:207], v7 offset:3072
  v_lshlrev_b32 v5, 10, v1
  v_lshl_add_u32 v5, v2, 3, v5
  s_lshl_b32 s76, s72, 17
  s_lshl_b32 s77, s3, 15
  s_add_u32 s76, s76, s77
  s_lshl_b32 s77, s73, 14
  s_add_u32 s76, s76, s77
  s_lshl_b32 s77, s68, 7
  s_add_u32 s76, s76, s77
  s_waitcnt lgkmcnt(8)
  v_pk_add_f32 v[80:81], v[80:81], v[160:161]
  v_pk_add_f32 v[82:83], v[82:83], v[162:163]
  v_pk_add_f32 v[84:85], v[84:85], v[164:165]
  v_pk_add_f32 v[86:87], v[86:87], v[166:167]
  v_pk_add_f32 v[88:89], v[88:89], v[168:169]
  v_pk_add_f32 v[90:91], v[90:91], v[170:171]
  v_pk_add_f32 v[92:93], v[92:93], v[172:173]
  v_pk_add_f32 v[94:95], v[94:95], v[174:175]
  s_waitcnt lgkmcnt(4)
  v_pk_add_f32 v[80:81], v[80:81], v[176:177]
  v_pk_add_f32 v[82:83], v[82:83], v[178:179]
  v_pk_add_f32 v[84:85], v[84:85], v[180:181]
  v_pk_add_f32 v[86:87], v[86:87], v[182:183]
  v_pk_add_f32 v[88:89], v[88:89], v[184:185]
  v_pk_add_f32 v[90:91], v[90:91], v[186:187]
  v_pk_add_f32 v[92:93], v[92:93], v[188:189]
  v_pk_add_f32 v[94:95], v[94:95], v[190:191]
  s_waitcnt lgkmcnt(0)
  v_pk_add_f32 v[80:81], v[80:81], v[192:193]
  v_pk_add_f32 v[82:83], v[82:83], v[194:195]
  v_pk_add_f32 v[84:85], v[84:85], v[196:197]
  v_pk_add_f32 v[86:87], v[86:87], v[198:199]
  v_pk_add_f32 v[88:89], v[88:89], v[200:201]
  v_pk_add_f32 v[90:91], v[90:91], v[202:203]
  v_pk_add_f32 v[92:93], v[92:93], v[204:205]
  v_pk_add_f32 v[94:95], v[94:95], v[206:207]
  v_cvt_pk_bf16_f32 v8, v80, v81
  v_cvt_pk_bf16_f32 v9, v82, v83
  buffer_store_dwordx2 v[8:9], v5, s[36:39], s76 offen offset:0
  v_cvt_pk_bf16_f32 v10, v84, v85
  v_cvt_pk_bf16_f32 v11, v86, v87
  buffer_store_dwordx2 v[10:11], v5, s[36:39], s76 offen offset:32
  v_cvt_pk_bf16_f32 v12, v88, v89
  v_cvt_pk_bf16_f32 v13, v90, v91
  buffer_store_dwordx2 v[12:13], v5, s[36:39], s76 offen offset:64
  v_cvt_pk_bf16_f32 v14, v92, v93
  v_cvt_pk_bf16_f32 v15, v94, v95
  buffer_store_dwordx2 v[14:15], v5, s[36:39], s76 offen offset:96
  s_branch L_end
L_p2_special:
  s_waitcnt vmcnt(0)
  s_lshl_b32 s65, s3, 4
  v_lshlrev_b32 v72, 8, v2
  v_add3_u32 v72, v72, v1, s65
  v_add_u32 v64, 0, v72
  v_lshlrev_b32 v64, 2, v64
  v_cvt_pk_bf16_f32 v66, v176, v184
  v_add_u32 v64, 147456, v64
  ds_write_b32 v64, v66
  v_add_u32 v64, 64, v72
  v_lshlrev_b32 v64, 2, v64
  v_cvt_pk_bf16_f32 v66, v177, v185
  v_add_u32 v64, 147456, v64
  ds_write_b32 v64, v66
  v_add_u32 v64, 128, v72
  v_lshlrev_b32 v64, 2, v64
  v_cvt_pk_bf16_f32 v66, v178, v186
  v_add_u32 v64, 147456, v64
  ds_write_b32 v64, v66
  v_add_u32 v64, 192, v72
  v_lshlrev_b32 v64, 2, v64
  v_cvt_pk_bf16_f32 v66, v179, v187
  v_add_u32 v64, 147456, v64
  ds_write_b32 v64, v66
  v_add_u32 v64, 1024, v72
  v_lshlrev_b32 v64, 2, v64
  v_cvt_pk_bf16_f32 v66, v180, v188
  v_add_u32 v64, 147456, v64
  ds_write_b32 v64, v66
  v_add_u32 v64, 1088, v72
  v_lshlrev_b32 v64, 2, v64
  v_cvt_pk_bf16_f32 v66, v181, v189
  v_add_u32 v64, 147456, v64
  ds_write_b32 v64, v66
  v_add_u32 v64, 1152, v72
  v_lshlrev_b32 v64, 2, v64
  v_cvt_pk_bf16_f32 v66, v182, v190
  v_add_u32 v64, 147456, v64
  ds_write_b32 v64, v66
  v_add_u32 v64, 1216, v72
  v_lshlrev_b32 v64, 2, v64
  v_cvt_pk_bf16_f32 v66, v183, v191
  v_add_u32 v64, 147456, v64
  ds_write_b32 v64, v66
  s_waitcnt lgkmcnt(0)
  s_barrier
  v_sub_u32 v64, 2048, v72
  v_and_b32 v64, 2047, v64
  v_lshlrev_b32 v64, 2, v64
  v_add_u32 v64, 147456, v64
  ds_read_b32 v24, v64
  v_sub_u32 v64, 1984, v72
  v_and_b32 v64, 2047, v64
  v_lshlrev_b32 v64, 2, v64
  v_add_u32 v64, 147456, v64
  ds_read_b32 v25, v64
  v_sub_u32 v64, 1920, v72
  v_and_b32 v64, 2047, v64
  v_lshlrev_b32 v64, 2, v64
  v_add_u32 v64, 147456, v64
  ds_read_b32 v26, v64
  v_sub_u32 v64, 1856, v72
  v_and_b32 v64, 2047, v64
  v_lshlrev_b32 v64, 2, v64
  v_add_u32 v64, 147456, v64
  ds_read_b32 v27, v64
  v_sub_u32 v64, 1024, v72
  v_and_b32 v64, 2047, v64
  v_lshlrev_b32 v64, 2, v64
  v_add_u32 v64, 147456, v64
  ds_read_b32 v28, v64
  v_sub_u32 v64, 960, v72
  v_and_b32 v64, 2047, v64
  v_lshlrev_b32 v64, 2, v64
  v_add_u32 v64, 147456, v64
  ds_read_b32 v29, v64
  v_sub_u32 v64, 896, v72
  v_and_b32 v64, 2047, v64
  v_lshlrev_b32 v64, 2, v64
  v_add_u32 v64, 147456, v64
  ds_read_b32 v30, v64
  v_sub_u32 v64, 832, v72
  v_and_b32 v64, 2047, v64
  v_lshlrev_b32 v64, 2, v64
  v_add_u32 v64, 147456, v64
  ds_read_b32 v31, v64
  s_waitcnt lgkmcnt(0)
  v_lshlrev_b32 v64, 16, v56
  v_and_b32 v65, 0xffff0000, v56
  v_lshlrev_b32 v70, 16, v24
  v_and_b32 v71, 0xffff0000, v24
  v_mul_f32 v66, v176, v216
  v_fma_f32 v66, -v184, v224, v66
  v_fma_f32 v66, v70, v64, v66
  v_fma_f32 v66, v71, v65, v66
  v_mul_f32 v67, v176, v224
  v_fma_f32 v67, v184, v216, v67
  v_fma_f32 v67, v70, v65, v67
  v_fma_f32 v67, -v71, v64, v67
  v_cvt_pk_bf16_f32 v192, v66, -v67
  v_lshlrev_b32 v64, 16, v57
  v_and_b32 v65, 0xffff0000, v57
  v_lshlrev_b32 v70, 16, v25
  v_and_b32 v71, 0xffff0000, v25
  v_mul_f32 v66, v177, v217
  v_fma_f32 v66, -v185, v225, v66
  v_fma_f32 v66, v70, v64, v66
  v_fma_f32 v66, v71, v65, v66
  v_mul_f32 v67, v177, v225
  v_fma_f32 v67, v185, v217, v67
  v_fma_f32 v67, v70, v65, v67
  v_fma_f32 v67, -v71, v64, v67
  v_cvt_pk_bf16_f32 v193, v66, -v67
  v_lshlrev_b32 v64, 16, v58
  v_and_b32 v65, 0xffff0000, v58
  v_lshlrev_b32 v70, 16, v26
  v_and_b32 v71, 0xffff0000, v26
  v_mul_f32 v66, v178, v218
  v_fma_f32 v66, -v186, v226, v66
  v_fma_f32 v66, v70, v64, v66
  v_fma_f32 v66, v71, v65, v66
  v_mul_f32 v67, v178, v226
  v_fma_f32 v67, v186, v218, v67
  v_fma_f32 v67, v70, v65, v67
  v_fma_f32 v67, -v71, v64, v67
  v_cvt_pk_bf16_f32 v194, v66, -v67
  v_lshlrev_b32 v64, 16, v59
  v_and_b32 v65, 0xffff0000, v59
  v_lshlrev_b32 v70, 16, v27
  v_and_b32 v71, 0xffff0000, v27
  v_mul_f32 v66, v179, v219
  v_fma_f32 v66, -v187, v227, v66
  v_fma_f32 v66, v70, v64, v66
  v_fma_f32 v66, v71, v65, v66
  v_mul_f32 v67, v179, v227
  v_fma_f32 v67, v187, v219, v67
  v_fma_f32 v67, v70, v65, v67
  v_fma_f32 v67, -v71, v64, v67
  v_cvt_pk_bf16_f32 v195, v66, -v67
  v_lshlrev_b32 v64, 16, v60
  v_and_b32 v65, 0xffff0000, v60
  v_lshlrev_b32 v70, 16, v28
  v_and_b32 v71, 0xffff0000, v28
  v_mul_f32 v66, v180, v220
  v_fma_f32 v66, -v188, v228, v66
  v_fma_f32 v66, v70, v64, v66
  v_fma_f32 v66, v71, v65, v66
  v_mul_f32 v67, v180, v228
  v_fma_f32 v67, v188, v220, v67
  v_fma_f32 v67, v70, v65, v67
  v_fma_f32 v67, -v71, v64, v67
  v_cvt_pk_bf16_f32 v196, v66, -v67
  v_lshlrev_b32 v64, 16, v61
  v_and_b32 v65, 0xffff0000, v61
  v_lshlrev_b32 v70, 16, v29
  v_and_b32 v71, 0xffff0000, v29
  v_mul_f32 v66, v181, v221
  v_fma_f32 v66, -v189, v229, v66
  v_fma_f32 v66, v70, v64, v66
  v_fma_f32 v66, v71, v65, v66
  v_mul_f32 v67, v181, v229
  v_fma_f32 v67, v189, v221, v67
  v_fma_f32 v67, v70, v65, v67
  v_fma_f32 v67, -v71, v64, v67
  v_cvt_pk_bf16_f32 v197, v66, -v67
  v_lshlrev_b32 v64, 16, v62
  v_and_b32 v65, 0xffff0000, v62
  v_lshlrev_b32 v70, 16, v30
  v_and_b32 v71, 0xffff0000, v30
  v_mul_f32 v66, v182, v222
  v_fma_f32 v66, -v190, v230, v66
  v_fma_f32 v66, v70, v64, v66
  v_fma_f32 v66, v71, v65, v66
  v_mul_f32 v67, v182, v230
  v_fma_f32 v67, v190, v222, v67
  v_fma_f32 v67, v70, v65, v67
  v_fma_f32 v67, -v71, v64, v67
  v_cvt_pk_bf16_f32 v198, v66, -v67
  v_lshlrev_b32 v64, 16, v63
  v_and_b32 v65, 0xffff0000, v63
  v_lshlrev_b32 v70, 16, v31
  v_and_b32 v71, 0xffff0000, v31
  v_mul_f32 v66, v183, v223
  v_fma_f32 v66, -v191, v231, v66
  v_fma_f32 v66, v70, v64, v66
  v_fma_f32 v66, v71, v65, v66
  v_mul_f32 v67, v183, v231
  v_fma_f32 v67, v191, v223, v67
  v_fma_f32 v67, v70, v65, v67
  v_fma_f32 v67, -v71, v64, v67
  v_cvt_pk_bf16_f32 v199, v66, -v67
  s_branch L_p2_join
L_end:
  s_endpgm
.section .rodata,"a"
.p2align 6
.amdhsa_kernel gated_mix__spectral_gfnet__dense_activation_mish__prompt_kernel
  .amdhsa_next_free_vgpr 256
  .amdhsa_next_free_sgpr 102
  .amdhsa_accum_offset 256
  .amdhsa_group_segment_fixed_size 0
  .amdhsa_kernarg_size 88
  .amdhsa_user_sgpr_count 2
  .amdhsa_user_sgpr_kernarg_segment_ptr 1
  .amdhsa_system_sgpr_workgroup_id_x 1
.end_amdhsa_kernel
```
